```python
import torch

def _softmax(x, axis=-1):
    return torch.softmax(x, dim=axis)
def _gelu(x):
    return torch.nn.functional.gelu(x, approximate="tanh")
def _silu(x):
    return torch.nn.functional.silu(x)
def _sigmoid(x):
    return torch.sigmoid(x)
def _layernorm(x, axis=-1, eps=1e-5):
    m = x.mean(dim=axis, keepdim=True)
    v = x.var(dim=axis, keepdim=True, unbiased=False)
    return (x - m) / torch.sqrt(v + eps)
def _scatter_add(tgt, idx, src, axis=0):
    return tgt.clone().index_add_(axis, idx, src)
def _segment_sum(src, seg, n):
    out = torch.zeros((n,) + src.shape[1:], dtype=src.dtype)
    return out.index_add_(0, seg, src)
def _pad(x, pw):
    flat = tuple(v for pair in reversed(pw) for v in pair)
    return torch.nn.functional.pad(x, flat)

kernel_name = 'concat_heads__mha_block__grouped_kv_mqa__prompt'

def setup_inputs():

    _w = (lambda a: (lambda t: t.to(torch.bfloat16) if t.is_floating_point() else t)(torch.as_tensor(a)))
    def _A_setup():
        B, S, D, H = 1, 2048, 640, 32
        return {
            "x": _w((lambda *s: torch.randn(*s, dtype=torch.bfloat16) * 0.2)(B, S, D)),
            "wqkv": _w((lambda *s: torch.randn(*s, dtype=torch.bfloat16) * 0.2)(D, 3 * D)),
            "wo": _w((lambda *s: torch.randn(*s, dtype=torch.bfloat16) * 0.05)(D, D)),
        }
    _A_in = _A_setup()

    def _B_setup():
        B, S, D, H = 1, 2048, 640, 32
        Dh = D // H
        return {
            "x": _w((lambda *s: torch.randn(*s, dtype=torch.bfloat16) * 0.05)(B, S, D)),
            "wq": _w((lambda *s: torch.randn(*s, dtype=torch.bfloat16) * 0.8)(D, H * Dh)),
            "wk": _w((lambda *s: torch.randn(*s, dtype=torch.bfloat16) * 0.8)(D, Dh)),
            "wv": _w((lambda *s: torch.randn(*s, dtype=torch.bfloat16) * 0.1)(D, Dh)),
            "wo": _w((lambda *s: torch.randn(*s, dtype=torch.bfloat16) * 0.1)(H * Dh, D)),
        }
    _B_in = _B_setup()

    return {
        "A_x": _A_in["x"],
        "A_wqkv": _A_in["wqkv"],
        "A_wo": _A_in["wo"],
        "B_x": _B_in["x"],
        "B_wq": _B_in["wq"],
        "B_wk": _B_in["wk"],
        "B_wv": _B_in["wv"],
        "B_wo": _B_in["wo"],
    }

def reference(A_x, A_wqkv, A_wo, B_x, B_wq, B_wk, B_wv, B_wo):
    def _A_ref(x, wqkv, wo):
        B, S, D = x.shape
        H = 32
        Dh = D // H
        qkv = (lambda x, *d: x.permute(*d))((x @ wqkv).reshape(B, S, 3, H, Dh), 2, 0, 3, 1, 4)
        q, k, v = qkv[0], qkv[1], qkv[2]
        scores = torch.einsum("bhqd,bhkd->bhqk", q, k) * (Dh ** -0.5)
        p = _softmax(scores, axis=-1)
        o = torch.einsum("bhqk,bhkd->bhqd", p, v)
        return (lambda x, *d: x.permute(*d))(o, 0, 2, 1, 3).reshape(B, S, D) @ wo

    def _B_ref(x, wq, wk, wv, wo):
        B, S, D = x.shape
        H = 32
        Dh = D // H
        q = (lambda x, *d: x.permute(*d))((x @ wq).reshape(B, S, H, Dh), 0, 2, 1, 3)
        k = x @ wk
        v = x @ wv
        scores = torch.einsum("bhqd,bkd->bhqk", q, k) * (Dh ** -0.5)
        p = _softmax(scores, axis=-1)
        o = torch.einsum("bhqk,bkd->bhqd", p, v)
        return (lambda x, *d: x.permute(*d))(o, 0, 2, 1, 3).reshape(B, S, H * Dh) @ wo

    a = _A_ref(A_x, A_wqkv, A_wo)
    b = _B_ref(B_x, B_wq, B_wk, B_wv, B_wo)
    return torch.concatenate([a, b], axis=-1)
```

```asm
; @launch grid=(256,1,1) block=(512,1,1) lds=163840
.amdgcn_target "amdgcn-amd-amdhsa--gfx950"
.text
.globl concat_heads__mha_block__grouped_kv_mqa__prompt_kernel
.p2align 8
.type concat_heads__mha_block__grouped_kv_mqa__prompt_kernel,@function
concat_heads__mha_block__grouped_kv_mqa__prompt_kernel:
    s_getpc_b64 s[96:97]
    s_cmp_ge_u32 s2, 256
    s_cbranch_scc1 L_end
    s_load_dwordx16 s[64:79], s[0:1], 0
    s_load_dwordx4 s[80:83], s[0:1], 64
    s_load_dwordx2 s[84:85], s[0:1], 80
    s_memrealtime s[46:47]
    v_lshrrev_b32 v2, 6, v0
    v_and_b32 v1, 63, v0
    s_getreg_b32 s24, hwreg(HW_REG_XCC_ID, 0, 3)
    v_readfirstlane_b32 s20, v2
    s_and_b32 s23, s2, 7
    s_lshr_b32 s24, s2, 3
    s_lshr_b32 s29, s23, 1
    s_and_b32 s28, s23, 1
    s_lshl_b32 s28, s28, 3
    s_and_b32 s25, s24, 7
    s_add_u32 s28, s28, s25
    s_lshr_b32 s30, s24, 3
    s_and_b32 s22, s20, 3
    s_lshr_b32 s38, s20, 2
    s_cmp_ge_u32 s20, 4
    s_cbranch_scc0 L_comp
    s_setprio 2
    s_cmp_eq_u32 s29, 3
    s_mov_b32 s31, 3840
    s_cmov_b32 s31, 1280
    s_mul_i32 s93, s30, 3
    s_add_u32 s93, s93, s25
    s_cmp_ge_u32 s93, 10
    s_cselect_b32 s23, 10, 0
    s_sub_u32 s93, s93, s23
    v_lshrrev_b32 v2, 3, v1
    s_lshl_b32 s23, s22, 5
    v_add_u32 v2, s23, v2
    v_mul_u32_u24 v2, 1280, v2
    v_and_b32 v3, 7, v1
    v_lshrrev_b32 v4, 4, v1
    v_xor_b32 v3, v3, v4
    v_xor_b32 v4, 4, v3
    v_lshl_add_u32 v36, v3, 4, v2
    v_lshl_add_u32 v37, v4, 4, v2
    v_add_u32 v37, 10240, v37
    v_add_u32 v38, 20480, v36
    v_add_u32 v39, 20480, v37
    s_lshl_b32 s41, s31, 6
    s_lshr_b32 s23, s22, 1
    s_mul_i32 s23, s23, 160
    s_and_b32 s24, s22, 1
    s_mul_i32 s24, s24, s31
    s_lshl_b32 s24, s24, 5
    s_add_u32 s40, s23, s24
    v_mov_b32 v9, s31
    v_add_u32 v2, 0, v1
    v_mul_u32_u24 v3, 6554, v2
    v_lshrrev_b32 v3, 16, v3
    v_mul_u32_u24 v4, 10, v3
    v_sub_u32 v4, v2, v4
    v_lshl_add_u32 v5, v4, 4, s40
    v_and_b32 v6, 3, v3
    v_and_b32 v7, 12, v3
    v_lshl_add_u32 v6, v7, 1, v6
    v_lshrrev_b32 v7, 4, v3
    v_lshl_add_u32 v6, v7, 2, v6
    v_mad_u32_u24 v40, v6, v9, v5
    v_add_u32 v2, 64, v1
    v_mul_u32_u24 v3, 6554, v2
    v_lshrrev_b32 v3, 16, v3
    v_mul_u32_u24 v4, 10, v3
    v_sub_u32 v4, v2, v4
    v_lshl_add_u32 v5, v4, 4, s40
    v_and_b32 v6, 3, v3
    v_and_b32 v7, 12, v3
    v_lshl_add_u32 v6, v7, 1, v6
    v_lshrrev_b32 v7, 4, v3
    v_lshl_add_u32 v6, v7, 2, v6
    v_mad_u32_u24 v41, v6, v9, v5
    v_add_u32 v2, 128, v1
    v_mul_u32_u24 v3, 6554, v2
    v_lshrrev_b32 v3, 16, v3
    v_mul_u32_u24 v4, 10, v3
    v_sub_u32 v4, v2, v4
    v_lshl_add_u32 v5, v4, 4, s40
    v_and_b32 v6, 3, v3
    v_and_b32 v7, 12, v3
    v_lshl_add_u32 v6, v7, 1, v6
    v_lshrrev_b32 v7, 4, v3
    v_lshl_add_u32 v6, v7, 2, v6
    v_mad_u32_u24 v42, v6, v9, v5
    v_add_u32 v2, 192, v1
    v_mul_u32_u24 v3, 6554, v2
    v_lshrrev_b32 v3, 16, v3
    v_mul_u32_u24 v4, 10, v3
    v_sub_u32 v4, v2, v4
    v_lshl_add_u32 v5, v4, 4, s40
    v_and_b32 v6, 3, v3
    v_and_b32 v7, 12, v3
    v_lshl_add_u32 v6, v7, 1, v6
    v_lshrrev_b32 v7, 4, v3
    v_lshl_add_u32 v6, v7, 2, v6
    v_mad_u32_u24 v43, v6, v9, v5
    v_add_u32 v2, 256, v1
    v_mul_u32_u24 v3, 6554, v2
    v_lshrrev_b32 v3, 16, v3
    v_mul_u32_u24 v4, 10, v3
    v_sub_u32 v4, v2, v4
    v_lshl_add_u32 v5, v4, 4, s40
    v_and_b32 v6, 3, v3
    v_and_b32 v7, 12, v3
    v_lshl_add_u32 v6, v7, 1, v6
    v_lshrrev_b32 v7, 4, v3
    v_lshl_add_u32 v6, v7, 2, v6
    v_mad_u32_u24 v44, v6, v9, v5
    s_mul_i32 s23, s22, 768
    v_lshlrev_b32 v48, 4, v1
    v_add_u32 v48, s23, v48
    s_lshl_b32 s35, s93, 7
    s_mul_i32 s36, s93, s41
    s_mul_i32 s37, s93, 2560
    s_mul_i32 s23, s28, 163840
    s_mov_b32 s10, 163840
    s_mov_b32 s11, 0x00020000
    s_mov_b32 s15, 0x00020000
    s_mov_b32 s18, 25600
    s_mov_b32 s19, 0x00020000
    s_cmp_eq_u32 s29, 3
    s_cselect_b32 s24, 0, s29
    s_mov_b32 s14, 2457600
    s_cmov_b32 s14, 819200
    s_waitcnt lgkmcnt(0)
    s_cselect_b32 s8, s70, s64
    s_cselect_b32 s9, s71, s65
    s_cselect_b32 s12, s72, s66
    s_cselect_b32 s13, s73, s67
    s_add_u32 s8, s8, s23
    s_addc_u32 s9, s9, 0
    s_mul_i32 s24, s24, 1280
    s_mul_i32 s23, s30, 320
    s_add_u32 s23, s23, s24
    s_add_u32 s12, s12, s23
    s_addc_u32 s13, s13, 0
    s_sub_u32 s14, s14, s23
    s_cmp_lt_u32 s30, 2
    s_cselect_b32 s16, s74, s76
    s_cselect_b32 s17, s75, s77
    s_lshl_b32 s23, s22, 12
    s_mul_i32 s24, s22, 5120
    s_add_u32 s24, s24, 16384
    s_mul_i32 s25, s22, 768
    s_add_u32 s25, s25, 36864
    s_mov_b32 s32, 0
    s_mov_b32 s27, 0
    s_lshl_b32 s98, s22, 7
    s_add_u32 s98, s98, L_stset - concat_heads__mha_block__grouped_kv_mqa__prompt_kernel
    s_cmp_eq_u32 s29, 3
    s_cbranch_scc1 L_llB
L_llA:
    s_add_u32 m0, s23, 0
    s_nop 0
    buffer_load_dwordx4 v36, s[8:11], s35 offen lds
    s_add_u32 m0, s23, 1024
    s_nop 0
    buffer_load_dwordx4 v37, s[8:11], s35 offen lds
    s_add_u32 m0, s23, 2048
    s_nop 0
    buffer_load_dwordx4 v38, s[8:11], s35 offen lds
    s_add_u32 m0, s23, 3072
    s_nop 0
    buffer_load_dwordx4 v39, s[8:11], s35 offen lds
    s_add_u32 m0, s24, 0
    s_nop 0
    buffer_load_dwordx4 v40, s[12:15], s36 offen lds
    s_add_u32 m0, s24, 1024
    s_nop 0
    buffer_load_dwordx4 v41, s[12:15], s36 offen lds
    s_add_u32 m0, s24, 2048
    s_nop 0
    buffer_load_dwordx4 v42, s[12:15], s36 offen lds
    s_add_u32 m0, s24, 3072
    s_nop 0
    buffer_load_dwordx4 v43, s[12:15], s36 offen lds
    s_add_u32 m0, s24, 4096
    s_nop 0
    buffer_load_dwordx4 v44, s[12:15], s36 offen lds
    s_add_u32 s35, s35, 128
    s_add_u32 s36, s36, s41
    s_cmp_eq_u32 s35, 1280
    s_cselect_b32 s35, 0, s35
    s_cselect_b32 s36, 0, s36
    s_cselect_b32 s37, 0, s37
    s_add_u32 s32, s32, 1
    s_and_b32 s32, s32, 3
    s_mov_b32 s40, 39424
    s_cmp_eq_u32 s32, 0
    s_cmov_b32 s40, 4294849024
    s_add_u32 s23, s23, s40
    s_add_u32 s24, s24, s40
    s_add_u32 s25, s25, s40
    s_add_u32 s27, s27, 1
    s_cmp_lt_u32 s27, 2
    s_cbranch_scc1 L_llA
    s_waitcnt vmcnt(9)
    s_barrier
    s_cmp_lt_u32 s27, 10
    s_cbranch_scc1 L_llA
    s_waitcnt vmcnt(0)
    s_barrier
    s_branch L_ldone
L_llB:
    s_add_u32 m0, s23, 0
    s_nop 0
    buffer_load_dwordx4 v36, s[8:11], s35 offen lds
    s_add_u32 m0, s23, 1024
    s_nop 0
    buffer_load_dwordx4 v37, s[8:11], s35 offen lds
    s_add_u32 m0, s23, 2048
    s_nop 0
    buffer_load_dwordx4 v38, s[8:11], s35 offen lds
    s_add_u32 m0, s23, 3072
    s_nop 0
    buffer_load_dwordx4 v39, s[8:11], s35 offen lds
    s_add_u32 m0, s24, 0
    s_nop 0
    buffer_load_dwordx4 v40, s[12:15], s36 offen lds
    s_add_u32 m0, s24, 1024
    s_nop 0
    buffer_load_dwordx4 v41, s[12:15], s36 offen lds
    s_add_u32 m0, s24, 2048
    s_nop 0
    buffer_load_dwordx4 v42, s[12:15], s36 offen lds
    s_add_u32 m0, s24, 3072
    s_nop 0
    buffer_load_dwordx4 v43, s[12:15], s36 offen lds
    s_add_u32 m0, s24, 4096
    s_nop 0
    buffer_load_dwordx4 v44, s[12:15], s36 offen lds
    s_mov_b32 m0, s25
    s_cmp_eq_u32 s22, 3
    s_cbranch_scc1 L_ne
    buffer_load_dwordx4 v48, s[16:19], s37 offen lds
L_ne:
    s_add_u32 s37, s37, 2560
    s_add_u32 s35, s35, 128
    s_add_u32 s36, s36, s41
    s_cmp_eq_u32 s35, 1280
    s_cselect_b32 s35, 0, s35
    s_cselect_b32 s36, 0, s36
    s_cselect_b32 s37, 0, s37
    s_add_u32 s32, s32, 1
    s_and_b32 s32, s32, 3
    s_mov_b32 s40, 39424
    s_cmp_eq_u32 s32, 0
    s_cmov_b32 s40, 4294849024
    s_add_u32 s23, s23, s40
    s_add_u32 s24, s24, s40
    s_add_u32 s25, s25, s40
    s_add_u32 s27, s27, 1
    s_cmp_lt_u32 s27, 2
    s_cbranch_scc1 L_llB
    s_waitcnt vmcnt(9)
    s_barrier
    s_cmp_lt_u32 s27, 10
    s_cbranch_scc1 L_llB
    s_waitcnt vmcnt(0)
    s_barrier
L_ldone:
    s_cmp_lg_u32 s20, 4
    s_cbranch_scc1 L_nn
    v_mov_b32 v2, 0
    s_mov_b32 s43, 1000000
L_gn1:
    global_load_dwordx2 v[10:11], v2, s[82:83] sc1
    s_waitcnt vmcnt(0)
    v_readfirstlane_b32 s86, v10
    v_readfirstlane_b32 s87, v11
    s_sub_u32 s43, s43, 1
    s_cbranch_scc1 L_gd1
    s_cmp_eq_u32 s86, 0
    s_cbranch_scc1 L_gn1
L_gd1:
    v_mov_b32 v2, 163808
    ds_write_b64 v2, v[10:11]
L_nn:
    s_cmp_lg_u32 s29, 2
    s_cbranch_scc1 L_stset
    v_and_b32 v2, 31, v1
    v_mul_u32_u24 v2, 336, v2
    s_mul_i32 s23, s22, 10752
    s_add_u32 s23, s23, 79168
    v_add_u32 v2, s23, v2
    v_mov_b32 v4, 0x3f803f80
    v_mov_b32 v5, 0x3f803f80
    v_mov_b32 v6, 0x3f803f80
    v_mov_b32 v7, 0x3f803f80
    ds_write_b128 v2, v[4:7]
    s_branch L_stset
L_comp:
    s_lshl_b32 s98, s20, 7
    s_add_u32 s98, s98, L_comp - concat_heads__mha_block__grouped_kv_mqa__prompt_kernel
    s_load_dword s99, s[96:97], s98
    s_add_u32 s98, s98, 512
    s_load_dword s99, s[96:97], s98
    s_add_u32 s98, s98, 512
    s_load_dword s99, s[96:97], s98
    s_add_u32 s98, s98, 512
    s_load_dword s99, s[96:97], s98
    s_add_u32 s98, s98, 512
    s_load_dword s99, s[96:97], s98
    s_add_u32 s98, s98, 512
    s_load_dword s99, s[96:97], s98
    s_add_u32 s98, s98, 512
    s_load_dword s99, s[96:97], s98
    s_add_u32 s98, s98, 512
    s_load_dword s99, s[96:97], s98
    s_add_u32 s98, s98, 512
    s_load_dword s99, s[96:97], s98
    s_add_u32 s98, s98, 512
    s_load_dword s99, s[96:97], s98
    s_add_u32 s98, s98, 512
    s_load_dword s99, s[96:97], s98
    s_add_u32 s98, s98, 512
    s_load_dword s99, s[96:97], s98
    s_add_u32 s98, s98, 512
    s_load_dword s99, s[96:97], s98
    s_add_u32 s98, s98, 512
    s_load_dword s99, s[96:97], s98
    s_add_u32 s98, s98, 512
    s_load_dword s99, s[96:97], s98
    s_add_u32 s98, s98, 512
    s_load_dword s99, s[96:97], s98
    s_add_u32 s98, s98, 512
    s_load_dword s99, s[96:97], s98
    s_add_u32 s98, s98, 512
    s_lshr_b32 s42, s20, 1
    s_and_b32 s92, s20, 1
    v_and_b32 v2, 15, v1
    v_lshrrev_b32 v3, 4, v1
    v_lshrrev_b32 v4, 1, v2
    v_xor_b32 v4, v4, v3
    v_xor_b32 v5, 4, v4
    v_lshlrev_b32 v6, 7, v2
    v_lshl_add_u32 v4, v4, 4, v6
    v_lshl_add_u32 v5, v5, 4, v6
    s_lshl_b32 s23, s42, 13
    v_add_u32 v12, s23, v4
    v_add_u32 v13, s23, v5
    s_and_b32 s40, s30, 1
    s_lshl_b32 s40, s40, 1
    s_add_u32 s40, s40, s92
    s_lshl_b32 s25, s40, 11
    v_add_u32 v16, s25, v12
    v_add_u32 v17, s25, v13
    v_lshrrev_b32 v4, 2, v1
    v_mul_u32_u24 v4, 40, v1
    v_and_b32 v5, 3, v1
    s_mul_i32 s23, s92, 10240
    v_add_u32 v14, s23, v4
    v_lshrrev_b32 v4, 2, v2
    v_lshl_add_u32 v4, v3, 3, v4
    v_mul_u32_u24 v4, 40, v4
    v_lshl_add_u32 v15, v5, 3, v4
    s_waitcnt lgkmcnt(0)
    s_add_u32 s24, s2, s20
    s_cmp_lg_u32 s24, 0
    s_cbranch_scc1 L_nononce
    s_or_b32 s24, s46, 1
    v_mov_b32 v10, s24
    v_mov_b32 v11, s47
    v_mov_b32 v4, 0
    s_mov_b64 exec, 1
    global_store_dwordx2 v4, v[10:11], s[82:83] sc1
    s_mov_b64 exec, -1
L_nononce:
    v_pk_mov_b32 v[132:133], 0, 0
    v_pk_mov_b32 v[134:135], 0, 0
    v_pk_mov_b32 v[136:137], 0, 0
    v_pk_mov_b32 v[138:139], 0, 0
    v_pk_mov_b32 v[140:141], 0, 0
    v_pk_mov_b32 v[142:143], 0, 0
    v_pk_mov_b32 v[144:145], 0, 0
    v_pk_mov_b32 v[146:147], 0, 0
    v_pk_mov_b32 v[148:149], 0, 0
    v_pk_mov_b32 v[150:151], 0, 0
    v_pk_mov_b32 v[152:153], 0, 0
    v_pk_mov_b32 v[154:155], 0, 0
    v_pk_mov_b32 v[156:157], 0, 0
    v_pk_mov_b32 v[158:159], 0, 0
    v_pk_mov_b32 v[160:161], 0, 0
    v_pk_mov_b32 v[162:163], 0, 0
    v_pk_mov_b32 v[164:165], 0, 0
    v_pk_mov_b32 v[166:167], 0, 0
    v_pk_mov_b32 v[168:169], 0, 0
    v_pk_mov_b32 v[170:171], 0, 0
    v_pk_mov_b32 v[172:173], 0, 0
    v_pk_mov_b32 v[174:175], 0, 0
    v_pk_mov_b32 v[176:177], 0, 0
    v_pk_mov_b32 v[178:179], 0, 0
    v_pk_mov_b32 v[180:181], 0, 0
    v_pk_mov_b32 v[182:183], 0, 0
    v_pk_mov_b32 v[184:185], 0, 0
    v_pk_mov_b32 v[186:187], 0, 0
    v_pk_mov_b32 v[188:189], 0, 0
    v_pk_mov_b32 v[190:191], 0, 0
    v_pk_mov_b32 v[192:193], 0, 0
    v_pk_mov_b32 v[194:195], 0, 0
    v_pk_mov_b32 v[196:197], 0, 0
    v_pk_mov_b32 v[198:199], 0, 0
    v_pk_mov_b32 v[200:201], 0, 0
    v_pk_mov_b32 v[202:203], 0, 0
    v_pk_mov_b32 v[204:205], 0, 0
    v_pk_mov_b32 v[206:207], 0, 0
    v_pk_mov_b32 v[208:209], 0, 0
    v_pk_mov_b32 v[210:211], 0, 0
    v_mov_b32 v212, 0
    v_mov_b32 v213, 0
    v_mov_b32 v214, 0
    v_mov_b32 v215, 0
    v_mov_b32 v216, 0
    v_mov_b32 v217, 0
    v_mov_b32 v218, 0
    v_mov_b32 v219, 0
    s_cmp_eq_u32 s29, 1
    s_mov_b32 s34, 0x3ea52b5c
    s_cmov_b32 s34, 1.0
    v_mov_b32 v30, s34
    v_mov_b32 v31, s34
    s_mov_b32 s32, 0
    s_mov_b32 s27, 0
    s_cmp_eq_u32 s29, 2
    s_cbranch_scc1 L_F
    v_and_b32 v2, 15, v1
    v_lshrrev_b32 v3, 4, v1
    s_mul_i32 s23, s92, 21504
    s_mul_i32 s24, s42, 2560
    s_add_u32 s23, s23, s24
    s_add_u32 s23, s23, 78848
    v_mul_u32_u24 v5, 5376, v3
    v_add_u32 v5, s23, v5
    v_lshl_add_u32 v24, v2, 4, v5
    v_lshl_add_u32 v25, v2, 3, v5
    s_cmp_eq_u32 s29, 3
    s_cbranch_scc1 L_B
    v_add_u32 v18, s32, v12
    v_add_u32 v20, s32, v14
    v_add_u32 v19, s32, v13
    s_add_u32 s32, s32, 39424
    s_cmp_eq_u32 s32, 157696
    s_cselect_b32 s32, 0, s32
    s_barrier
    ds_read_b128 v[36:39], v18
    ds_read_b64_tr_b16 v[68:69], v20 offset:16384
    ds_read_b64_tr_b16 v[70:71], v20 offset:18944
    ds_read_b64_tr_b16 v[72:73], v20 offset:16392
    ds_read_b64_tr_b16 v[74:75], v20 offset:18952
    ds_read_b64_tr_b16 v[76:77], v20 offset:16400
    ds_read_b64_tr_b16 v[78:79], v20 offset:18960
    ds_read_b64_tr_b16 v[80:81], v20 offset:16408
    ds_read_b64_tr_b16 v[82:83], v20 offset:18968
    ds_read_b64_tr_b16 v[84:85], v20 offset:16416
    ds_read_b64_tr_b16 v[86:87], v20 offset:18976
    ds_read_b128 v[40:43], v18 offset:2048
    ds_read_b128 v[44:47], v18 offset:4096
    ds_read_b128 v[48:51], v18 offset:6144
    s_branch L_T_mid
.p2align 6
L_T_loop:
    s_barrier
    v_mfma_f32_16x16x32_bf16 v[132:135], v[88:91], v[52:55], v[132:135]
    ds_read_b128 v[36:39], v18
    v_mfma_f32_16x16x32_bf16 v[136:139], v[92:95], v[52:55], v[136:139]
    ds_read_b64_tr_b16 v[68:69], v20 offset:16384
    v_mfma_f32_16x16x32_bf16 v[140:143], v[96:99], v[52:55], v[140:143]
    ds_read_b64_tr_b16 v[70:71], v20 offset:18944
    v_mfma_f32_16x16x32_bf16 v[144:147], v[100:103], v[52:55], v[144:147]
    ds_read_b64_tr_b16 v[72:73], v20 offset:16392
    v_mfma_f32_16x16x32_bf16 v[148:151], v[104:107], v[52:55], v[148:151]
    ds_read_b64_tr_b16 v[74:75], v20 offset:18952
    v_mfma_f32_16x16x32_bf16 v[152:155], v[88:91], v[56:59], v[152:155]
    ds_read_b64_tr_b16 v[76:77], v20 offset:16400
    v_mfma_f32_16x16x32_bf16 v[156:159], v[92:95], v[56:59], v[156:159]
    ds_read_b64_tr_b16 v[78:79], v20 offset:18960
    v_mfma_f32_16x16x32_bf16 v[160:163], v[96:99], v[56:59], v[160:163]
    ds_read_b64_tr_b16 v[80:81], v20 offset:16408
    v_mfma_f32_16x16x32_bf16 v[164:167], v[100:103], v[56:59], v[164:167]
    ds_read_b64_tr_b16 v[82:83], v20 offset:18968
    v_mfma_f32_16x16x32_bf16 v[168:171], v[104:107], v[56:59], v[168:171]
    ds_read_b64_tr_b16 v[84:85], v20 offset:16416
    v_mfma_f32_16x16x32_bf16 v[172:175], v[88:91], v[60:63], v[172:175]
    ds_read_b64_tr_b16 v[86:87], v20 offset:18976
    v_mfma_f32_16x16x32_bf16 v[176:179], v[92:95], v[60:63], v[176:179]
    ds_read_b128 v[40:43], v18 offset:2048
    v_mfma_f32_16x16x32_bf16 v[180:183], v[96:99], v[60:63], v[180:183]
    ds_read_b128 v[44:47], v18 offset:4096
    v_mfma_f32_16x16x32_bf16 v[184:187], v[100:103], v[60:63], v[184:187]
    ds_read_b128 v[48:51], v18 offset:6144
    v_mfma_f32_16x16x32_bf16 v[188:191], v[104:107], v[60:63], v[188:191]
    v_mfma_f32_16x16x32_bf16 v[192:195], v[88:91], v[64:67], v[192:195]
    v_mfma_f32_16x16x32_bf16 v[196:199], v[92:95], v[64:67], v[196:199]
    v_mfma_f32_16x16x32_bf16 v[200:203], v[96:99], v[64:67], v[200:203]
    v_mfma_f32_16x16x32_bf16 v[204:207], v[100:103], v[64:67], v[204:207]
    v_mfma_f32_16x16x32_bf16 v[208:211], v[104:107], v[64:67], v[208:211]
L_T_mid:
    s_waitcnt lgkmcnt(0)
    v_mfma_f32_16x16x32_bf16 v[132:135], v[68:71], v[36:39], v[132:135]
    ds_read_b128 v[52:55], v19
    v_mfma_f32_16x16x32_bf16 v[136:139], v[72:75], v[36:39], v[136:139]
    ds_read_b64_tr_b16 v[88:89], v20 offset:21504
    v_mfma_f32_16x16x32_bf16 v[140:143], v[76:79], v[36:39], v[140:143]
    ds_read_b64_tr_b16 v[90:91], v20 offset:24064
    v_mfma_f32_16x16x32_bf16 v[144:147], v[80:83], v[36:39], v[144:147]
    ds_read_b64_tr_b16 v[92:93], v20 offset:21512
    v_mfma_f32_16x16x32_bf16 v[148:151], v[84:87], v[36:39], v[148:151]
    ds_read_b64_tr_b16 v[94:95], v20 offset:24072
    v_mfma_f32_16x16x32_bf16 v[152:155], v[68:71], v[40:43], v[152:155]
    ds_read_b64_tr_b16 v[96:97], v20 offset:21520
    v_mfma_f32_16x16x32_bf16 v[156:159], v[72:75], v[40:43], v[156:159]
    ds_read_b64_tr_b16 v[98:99], v20 offset:24080
    v_mfma_f32_16x16x32_bf16 v[160:163], v[76:79], v[40:43], v[160:163]
    ds_read_b64_tr_b16 v[100:101], v20 offset:21528
    v_mfma_f32_16x16x32_bf16 v[164:167], v[80:83], v[40:43], v[164:167]
    ds_read_b64_tr_b16 v[102:103], v20 offset:24088
    v_mfma_f32_16x16x32_bf16 v[168:171], v[84:87], v[40:43], v[168:171]
    ds_read_b64_tr_b16 v[104:105], v20 offset:21536
    v_mfma_f32_16x16x32_bf16 v[172:175], v[68:71], v[44:47], v[172:175]
    ds_read_b64_tr_b16 v[106:107], v20 offset:24096
    v_mfma_f32_16x16x32_bf16 v[176:179], v[72:75], v[44:47], v[176:179]
    ds_read_b128 v[56:59], v19 offset:2048
    v_mfma_f32_16x16x32_bf16 v[180:183], v[76:79], v[44:47], v[180:183]
    ds_read_b128 v[60:63], v19 offset:4096
    v_mfma_f32_16x16x32_bf16 v[184:187], v[80:83], v[44:47], v[184:187]
    ds_read_b128 v[64:67], v19 offset:6144
    v_mfma_f32_16x16x32_bf16 v[188:191], v[84:87], v[44:47], v[188:191]
    v_mfma_f32_16x16x32_bf16 v[192:195], v[68:71], v[48:51], v[192:195]
    v_mfma_f32_16x16x32_bf16 v[196:199], v[72:75], v[48:51], v[196:199]
    v_mfma_f32_16x16x32_bf16 v[200:203], v[76:79], v[48:51], v[200:203]
    v_mfma_f32_16x16x32_bf16 v[204:207], v[80:83], v[48:51], v[204:207]
    v_mfma_f32_16x16x32_bf16 v[208:211], v[84:87], v[48:51], v[208:211]
    v_add_u32 v18, s32, v12
    v_add_u32 v20, s32, v14
    v_add_u32 v19, s32, v13
    s_add_u32 s32, s32, 39424
    s_cmp_eq_u32 s32, 157696
    s_cselect_b32 s32, 0, s32
    s_add_u32 s27, s27, 1
    s_cmp_lt_u32 s27, 10
    s_waitcnt lgkmcnt(0)
    s_cbranch_scc1 L_T_loop
    v_mfma_f32_16x16x32_bf16 v[132:135], v[88:91], v[52:55], v[132:135]
    v_mfma_f32_16x16x32_bf16 v[136:139], v[92:95], v[52:55], v[136:139]
    v_mfma_f32_16x16x32_bf16 v[140:143], v[96:99], v[52:55], v[140:143]
    v_mfma_f32_16x16x32_bf16 v[144:147], v[100:103], v[52:55], v[144:147]
    v_mfma_f32_16x16x32_bf16 v[148:151], v[104:107], v[52:55], v[148:151]
    v_mfma_f32_16x16x32_bf16 v[152:155], v[88:91], v[56:59], v[152:155]
    v_mfma_f32_16x16x32_bf16 v[156:159], v[92:95], v[56:59], v[156:159]
    v_mfma_f32_16x16x32_bf16 v[160:163], v[96:99], v[56:59], v[160:163]
    v_mfma_f32_16x16x32_bf16 v[164:167], v[100:103], v[56:59], v[164:167]
    v_mfma_f32_16x16x32_bf16 v[168:171], v[104:107], v[56:59], v[168:171]
    v_mfma_f32_16x16x32_bf16 v[172:175], v[88:91], v[60:63], v[172:175]
    v_mfma_f32_16x16x32_bf16 v[176:179], v[92:95], v[60:63], v[176:179]
    v_mfma_f32_16x16x32_bf16 v[180:183], v[96:99], v[60:63], v[180:183]
    v_mfma_f32_16x16x32_bf16 v[184:187], v[100:103], v[60:63], v[184:187]
    v_mfma_f32_16x16x32_bf16 v[188:191], v[104:107], v[60:63], v[188:191]
    v_mfma_f32_16x16x32_bf16 v[192:195], v[88:91], v[64:67], v[192:195]
    v_mfma_f32_16x16x32_bf16 v[196:199], v[92:95], v[64:67], v[196:199]
    v_mfma_f32_16x16x32_bf16 v[200:203], v[96:99], v[64:67], v[200:203]
    v_mfma_f32_16x16x32_bf16 v[204:207], v[100:103], v[64:67], v[204:207]
    v_mfma_f32_16x16x32_bf16 v[208:211], v[104:107], v[64:67], v[208:211]
    v_pk_mul_f32 v[132:133], v[132:133], v[30:31]
    v_pk_mul_f32 v[134:135], v[134:135], v[30:31]
    v_cvt_pk_bf16_f32 v132, v132, v133
    v_cvt_pk_bf16_f32 v133, v134, v135
    ds_write_b64 v24, v[132:133] offset:0
    v_pk_mul_f32 v[136:137], v[136:137], v[30:31]
    v_pk_mul_f32 v[138:139], v[138:139], v[30:31]
    v_cvt_pk_bf16_f32 v136, v136, v137
    v_cvt_pk_bf16_f32 v137, v138, v139
    ds_write_b64 v24, v[136:137] offset:512
    v_pk_mul_f32 v[140:141], v[140:141], v[30:31]
    v_pk_mul_f32 v[142:143], v[142:143], v[30:31]
    v_cvt_pk_bf16_f32 v140, v140, v141
    v_cvt_pk_bf16_f32 v141, v142, v143
    ds_write_b64 v24, v[140:141] offset:8
    v_pk_mul_f32 v[144:145], v[144:145], v[30:31]
    v_pk_mul_f32 v[146:147], v[146:147], v[30:31]
    v_cvt_pk_bf16_f32 v144, v144, v145
    v_cvt_pk_bf16_f32 v145, v146, v147
    ds_write_b64 v24, v[144:145] offset:520
    v_pk_mul_f32 v[148:149], v[148:149], v[30:31]
    v_pk_mul_f32 v[150:151], v[150:151], v[30:31]
    v_cvt_pk_bf16_f32 v148, v148, v149
    v_cvt_pk_bf16_f32 v149, v150, v151
    ds_write_b64 v25, v[148:149] offset:1024
    v_pk_mul_f32 v[152:153], v[152:153], v[30:31]
    v_pk_mul_f32 v[154:155], v[154:155], v[30:31]
    v_cvt_pk_bf16_f32 v152, v152, v153
    v_cvt_pk_bf16_f32 v153, v154, v155
    ds_write_b64 v24, v[152:153] offset:256
    v_pk_mul_f32 v[156:157], v[156:157], v[30:31]
    v_pk_mul_f32 v[158:159], v[158:159], v[30:31]
    v_cvt_pk_bf16_f32 v156, v156, v157
    v_cvt_pk_bf16_f32 v157, v158, v159
    ds_write_b64 v24, v[156:157] offset:768
    v_pk_mul_f32 v[160:161], v[160:161], v[30:31]
    v_pk_mul_f32 v[162:163], v[162:163], v[30:31]
    v_cvt_pk_bf16_f32 v160, v160, v161
    v_cvt_pk_bf16_f32 v161, v162, v163
    ds_write_b64 v24, v[160:161] offset:264
    v_pk_mul_f32 v[164:165], v[164:165], v[30:31]
    v_pk_mul_f32 v[166:167], v[166:167], v[30:31]
    v_cvt_pk_bf16_f32 v164, v164, v165
    v_cvt_pk_bf16_f32 v165, v166, v167
    ds_write_b64 v24, v[164:165] offset:776
    v_pk_mul_f32 v[168:169], v[168:169], v[30:31]
    v_pk_mul_f32 v[170:171], v[170:171], v[30:31]
    v_cvt_pk_bf16_f32 v168, v168, v169
    v_cvt_pk_bf16_f32 v169, v170, v171
    ds_write_b64 v25, v[168:169] offset:1152
    v_pk_mul_f32 v[172:173], v[172:173], v[30:31]
    v_pk_mul_f32 v[174:175], v[174:175], v[30:31]
    v_cvt_pk_bf16_f32 v172, v172, v173
    v_cvt_pk_bf16_f32 v173, v174, v175
    ds_write_b64 v24, v[172:173] offset:1280
    v_pk_mul_f32 v[176:177], v[176:177], v[30:31]
    v_pk_mul_f32 v[178:179], v[178:179], v[30:31]
    v_cvt_pk_bf16_f32 v176, v176, v177
    v_cvt_pk_bf16_f32 v177, v178, v179
    ds_write_b64 v24, v[176:177] offset:1792
    v_pk_mul_f32 v[180:181], v[180:181], v[30:31]
    v_pk_mul_f32 v[182:183], v[182:183], v[30:31]
    v_cvt_pk_bf16_f32 v180, v180, v181
    v_cvt_pk_bf16_f32 v181, v182, v183
    ds_write_b64 v24, v[180:181] offset:1288
    v_pk_mul_f32 v[184:185], v[184:185], v[30:31]
    v_pk_mul_f32 v[186:187], v[186:187], v[30:31]
    v_cvt_pk_bf16_f32 v184, v184, v185
    v_cvt_pk_bf16_f32 v185, v186, v187
    ds_write_b64 v24, v[184:185] offset:1800
    v_pk_mul_f32 v[188:189], v[188:189], v[30:31]
    v_pk_mul_f32 v[190:191], v[190:191], v[30:31]
    v_cvt_pk_bf16_f32 v188, v188, v189
    v_cvt_pk_bf16_f32 v189, v190, v191
    ds_write_b64 v25, v[188:189] offset:2304
    v_pk_mul_f32 v[192:193], v[192:193], v[30:31]
    v_pk_mul_f32 v[194:195], v[194:195], v[30:31]
    v_cvt_pk_bf16_f32 v192, v192, v193
    v_cvt_pk_bf16_f32 v193, v194, v195
    ds_write_b64 v24, v[192:193] offset:1536
    v_pk_mul_f32 v[196:197], v[196:197], v[30:31]
    v_pk_mul_f32 v[198:199], v[198:199], v[30:31]
    v_cvt_pk_bf16_f32 v196, v196, v197
    v_cvt_pk_bf16_f32 v197, v198, v199
    ds_write_b64 v24, v[196:197] offset:2048
    v_pk_mul_f32 v[200:201], v[200:201], v[30:31]
    v_pk_mul_f32 v[202:203], v[202:203], v[30:31]
    v_cvt_pk_bf16_f32 v200, v200, v201
    v_cvt_pk_bf16_f32 v201, v202, v203
    ds_write_b64 v24, v[200:201] offset:1544
    v_pk_mul_f32 v[204:205], v[204:205], v[30:31]
    v_pk_mul_f32 v[206:207], v[206:207], v[30:31]
    v_cvt_pk_bf16_f32 v204, v204, v205
    v_cvt_pk_bf16_f32 v205, v206, v207
    ds_write_b64 v24, v[204:205] offset:2056
    v_pk_mul_f32 v[208:209], v[208:209], v[30:31]
    v_pk_mul_f32 v[210:211], v[210:211], v[30:31]
    v_cvt_pk_bf16_f32 v208, v208, v209
    v_cvt_pk_bf16_f32 v209, v210, v211
    ds_write_b64 v25, v[208:209] offset:2432
    s_branch L_stset
L_B:
    s_cmp_lt_u32 s30, 2
    s_cbranch_scc0 L_BV
    s_lshl_b32 s23, s42, 11
    s_add_u32 s23, s23, 122880
    v_and_b32 v6, 1, v3
    v_lshrrev_b32 v7, 1, v3
    s_lshl_b32 s25, s92, 8
    s_add_u32 s25, s25, s23
    v_lshlrev_b32 v8, 9, v6
    v_lshl_add_u32 v8, v7, 3, v8
    v_lshl_add_u32 v8, v2, 4, v8
    v_add_u32 v34, s25, v8
    s_lshl_b32 s25, s92, 7
    s_add_u32 s25, s25, s23
    s_add_u32 s25, s25, 1024
    v_lshlrev_b32 v8, 20, v3
    v_lshl_add_u32 v8, v2, 3, v8
    v_add_u32 v35, s25, v8
    v_add_u32 v18, s32, v12
    v_add_u32 v20, s32, v14
    v_add_u32 v19, s32, v13
    v_add_u32 v22, s32, v16
    v_add_u32 v23, s32, v17
    v_add_u32 v21, s32, v15
    s_add_u32 s32, s32, 39424
    s_cmp_eq_u32 s32, 157696
    s_cselect_b32 s32, 0, s32
    s_barrier
    ds_read_b128 v[36:39], v18
    ds_read_b64_tr_b16 v[68:69], v20 offset:16384
    ds_read_b64_tr_b16 v[70:71], v20 offset:18944
    ds_read_b64_tr_b16 v[72:73], v20 offset:16392
    ds_read_b64_tr_b16 v[74:75], v20 offset:18952
    ds_read_b64_tr_b16 v[76:77], v20 offset:16400
    ds_read_b64_tr_b16 v[78:79], v20 offset:18960
    ds_read_b64_tr_b16 v[80:81], v20 offset:16408
    ds_read_b64_tr_b16 v[82:83], v20 offset:18968
    ds_read_b64_tr_b16 v[84:85], v20 offset:16416
    ds_read_b64_tr_b16 v[86:87], v20 offset:18976
    ds_read_b128 v[40:43], v18 offset:2048
    ds_read_b128 v[44:47], v18 offset:4096
    ds_read_b128 v[48:51], v18 offset:6144
    ds_read_b128 v[108:111], v22
    ds_read_b64_tr_b16 v[116:117], v21 offset:36864
    ds_read_b64_tr_b16 v[118:119], v21 offset:37024
    ds_read_b64_tr_b16 v[120:121], v21 offset:36896
    ds_read_b64_tr_b16 v[122:123], v21 offset:37056
    s_branch L_TK_mid
.p2align 6
L_TK_loop:
    s_barrier
    v_mfma_f32_16x16x32_bf16 v[132:135], v[88:91], v[52:55], v[132:135]
    ds_read_b128 v[36:39], v18
    v_mfma_f32_16x16x32_bf16 v[136:139], v[92:95], v[52:55], v[136:139]
    ds_read_b64_tr_b16 v[68:69], v20 offset:16384
    v_mfma_f32_16x16x32_bf16 v[140:143], v[96:99], v[52:55], v[140:143]
    ds_read_b64_tr_b16 v[70:71], v20 offset:18944
    v_mfma_f32_16x16x32_bf16 v[144:147], v[100:103], v[52:55], v[144:147]
    ds_read_b64_tr_b16 v[72:73], v20 offset:16392
    v_mfma_f32_16x16x32_bf16 v[148:151], v[104:107], v[52:55], v[148:151]
    ds_read_b64_tr_b16 v[74:75], v20 offset:18952
    v_mfma_f32_16x16x32_bf16 v[152:155], v[88:91], v[56:59], v[152:155]
    ds_read_b64_tr_b16 v[76:77], v20 offset:16400
    v_mfma_f32_16x16x32_bf16 v[156:159], v[92:95], v[56:59], v[156:159]
    ds_read_b64_tr_b16 v[78:79], v20 offset:18960
    v_mfma_f32_16x16x32_bf16 v[160:163], v[96:99], v[56:59], v[160:163]
    ds_read_b64_tr_b16 v[80:81], v20 offset:16408
    v_mfma_f32_16x16x32_bf16 v[164:167], v[100:103], v[56:59], v[164:167]
    ds_read_b64_tr_b16 v[82:83], v20 offset:18968
    v_mfma_f32_16x16x32_bf16 v[168:171], v[104:107], v[56:59], v[168:171]
    ds_read_b64_tr_b16 v[84:85], v20 offset:16416
    v_mfma_f32_16x16x32_bf16 v[172:175], v[88:91], v[60:63], v[172:175]
    ds_read_b64_tr_b16 v[86:87], v20 offset:18976
    v_mfma_f32_16x16x32_bf16 v[176:179], v[92:95], v[60:63], v[176:179]
    ds_read_b128 v[40:43], v18 offset:2048
    v_mfma_f32_16x16x32_bf16 v[180:183], v[96:99], v[60:63], v[180:183]
    ds_read_b128 v[44:47], v18 offset:4096
    v_mfma_f32_16x16x32_bf16 v[184:187], v[100:103], v[60:63], v[184:187]
    ds_read_b128 v[48:51], v18 offset:6144
    v_mfma_f32_16x16x32_bf16 v[188:191], v[104:107], v[60:63], v[188:191]
    ds_read_b128 v[108:111], v22
    v_mfma_f32_16x16x32_bf16 v[192:195], v[88:91], v[64:67], v[192:195]
    ds_read_b64_tr_b16 v[116:117], v21 offset:36864
    v_mfma_f32_16x16x32_bf16 v[196:199], v[92:95], v[64:67], v[196:199]
    ds_read_b64_tr_b16 v[118:119], v21 offset:37024
    v_mfma_f32_16x16x32_bf16 v[200:203], v[96:99], v[64:67], v[200:203]
    ds_read_b64_tr_b16 v[120:121], v21 offset:36896
    v_mfma_f32_16x16x32_bf16 v[204:207], v[100:103], v[64:67], v[204:207]
    ds_read_b64_tr_b16 v[122:123], v21 offset:37056
    v_mfma_f32_16x16x32_bf16 v[208:211], v[104:107], v[64:67], v[208:211]
    v_mfma_f32_16x16x32_bf16 v[212:215], v[124:127], v[112:115], v[212:215]
    v_mfma_f32_16x16x32_bf16 v[216:219], v[128:131], v[112:115], v[216:219]
L_TK_mid:
    s_waitcnt lgkmcnt(0)
    v_mfma_f32_16x16x32_bf16 v[132:135], v[68:71], v[36:39], v[132:135]
    ds_read_b128 v[52:55], v19
    v_mfma_f32_16x16x32_bf16 v[136:139], v[72:75], v[36:39], v[136:139]
    ds_read_b64_tr_b16 v[88:89], v20 offset:21504
    v_mfma_f32_16x16x32_bf16 v[140:143], v[76:79], v[36:39], v[140:143]
    ds_read_b64_tr_b16 v[90:91], v20 offset:24064
    v_mfma_f32_16x16x32_bf16 v[144:147], v[80:83], v[36:39], v[144:147]
    ds_read_b64_tr_b16 v[92:93], v20 offset:21512
    v_mfma_f32_16x16x32_bf16 v[148:151], v[84:87], v[36:39], v[148:151]
    ds_read_b64_tr_b16 v[94:95], v20 offset:24072
    v_mfma_f32_16x16x32_bf16 v[152:155], v[68:71], v[40:43], v[152:155]
    ds_read_b64_tr_b16 v[96:97], v20 offset:21520
    v_mfma_f32_16x16x32_bf16 v[156:159], v[72:75], v[40:43], v[156:159]
    ds_read_b64_tr_b16 v[98:99], v20 offset:24080
    v_mfma_f32_16x16x32_bf16 v[160:163], v[76:79], v[40:43], v[160:163]
    ds_read_b64_tr_b16 v[100:101], v20 offset:21528
    v_mfma_f32_16x16x32_bf16 v[164:167], v[80:83], v[40:43], v[164:167]
    ds_read_b64_tr_b16 v[102:103], v20 offset:24088
    v_mfma_f32_16x16x32_bf16 v[168:171], v[84:87], v[40:43], v[168:171]
    ds_read_b64_tr_b16 v[104:105], v20 offset:21536
    v_mfma_f32_16x16x32_bf16 v[172:175], v[68:71], v[44:47], v[172:175]
    ds_read_b64_tr_b16 v[106:107], v20 offset:24096
    v_mfma_f32_16x16x32_bf16 v[176:179], v[72:75], v[44:47], v[176:179]
    ds_read_b128 v[56:59], v19 offset:2048
    v_mfma_f32_16x16x32_bf16 v[180:183], v[76:79], v[44:47], v[180:183]
    ds_read_b128 v[60:63], v19 offset:4096
    v_mfma_f32_16x16x32_bf16 v[184:187], v[80:83], v[44:47], v[184:187]
    ds_read_b128 v[64:67], v19 offset:6144
    v_mfma_f32_16x16x32_bf16 v[188:191], v[84:87], v[44:47], v[188:191]
    ds_read_b128 v[112:115], v23
    v_mfma_f32_16x16x32_bf16 v[192:195], v[68:71], v[48:51], v[192:195]
    ds_read_b64_tr_b16 v[124:125], v21 offset:38144
    v_mfma_f32_16x16x32_bf16 v[196:199], v[72:75], v[48:51], v[196:199]
    ds_read_b64_tr_b16 v[126:127], v21 offset:38304
    v_mfma_f32_16x16x32_bf16 v[200:203], v[76:79], v[48:51], v[200:203]
    ds_read_b64_tr_b16 v[128:129], v21 offset:38176
    v_mfma_f32_16x16x32_bf16 v[204:207], v[80:83], v[48:51], v[204:207]
    ds_read_b64_tr_b16 v[130:131], v21 offset:38336
    v_mfma_f32_16x16x32_bf16 v[208:211], v[84:87], v[48:51], v[208:211]
    v_mfma_f32_16x16x32_bf16 v[212:215], v[116:119], v[108:111], v[212:215]
    v_mfma_f32_16x16x32_bf16 v[216:219], v[120:123], v[108:111], v[216:219]
    v_add_u32 v18, s32, v12
    v_add_u32 v20, s32, v14
    v_add_u32 v19, s32, v13
    v_add_u32 v22, s32, v16
    v_add_u32 v23, s32, v17
    v_add_u32 v21, s32, v15
    s_add_u32 s32, s32, 39424
    s_cmp_eq_u32 s32, 157696
    s_cselect_b32 s32, 0, s32
    s_add_u32 s27, s27, 1
    s_cmp_lt_u32 s27, 10
    s_waitcnt lgkmcnt(0)
    s_cbranch_scc1 L_TK_loop
    v_mfma_f32_16x16x32_bf16 v[132:135], v[88:91], v[52:55], v[132:135]
    v_mfma_f32_16x16x32_bf16 v[136:139], v[92:95], v[52:55], v[136:139]
    v_mfma_f32_16x16x32_bf16 v[140:143], v[96:99], v[52:55], v[140:143]
    v_mfma_f32_16x16x32_bf16 v[144:147], v[100:103], v[52:55], v[144:147]
    v_mfma_f32_16x16x32_bf16 v[148:151], v[104:107], v[52:55], v[148:151]
    v_mfma_f32_16x16x32_bf16 v[152:155], v[88:91], v[56:59], v[152:155]
    v_mfma_f32_16x16x32_bf16 v[156:159], v[92:95], v[56:59], v[156:159]
    v_mfma_f32_16x16x32_bf16 v[160:163], v[96:99], v[56:59], v[160:163]
    v_mfma_f32_16x16x32_bf16 v[164:167], v[100:103], v[56:59], v[164:167]
    v_mfma_f32_16x16x32_bf16 v[168:171], v[104:107], v[56:59], v[168:171]
    v_mfma_f32_16x16x32_bf16 v[172:175], v[88:91], v[60:63], v[172:175]
    v_mfma_f32_16x16x32_bf16 v[176:179], v[92:95], v[60:63], v[176:179]
    v_mfma_f32_16x16x32_bf16 v[180:183], v[96:99], v[60:63], v[180:183]
    v_mfma_f32_16x16x32_bf16 v[184:187], v[100:103], v[60:63], v[184:187]
    v_mfma_f32_16x16x32_bf16 v[188:191], v[104:107], v[60:63], v[188:191]
    v_mfma_f32_16x16x32_bf16 v[192:195], v[88:91], v[64:67], v[192:195]
    v_mfma_f32_16x16x32_bf16 v[196:199], v[92:95], v[64:67], v[196:199]
    v_mfma_f32_16x16x32_bf16 v[200:203], v[96:99], v[64:67], v[200:203]
    v_mfma_f32_16x16x32_bf16 v[204:207], v[100:103], v[64:67], v[204:207]
    v_mfma_f32_16x16x32_bf16 v[208:211], v[104:107], v[64:67], v[208:211]
    v_mfma_f32_16x16x32_bf16 v[212:215], v[124:127], v[112:115], v[212:215]
    v_mfma_f32_16x16x32_bf16 v[216:219], v[128:131], v[112:115], v[216:219]
    v_pk_mul_f32 v[132:133], v[132:133], v[30:31]
    v_pk_mul_f32 v[134:135], v[134:135], v[30:31]
    v_cvt_pk_bf16_f32 v132, v132, v133
    v_cvt_pk_bf16_f32 v133, v134, v135
    ds_write_b64 v24, v[132:133] offset:0
    v_pk_mul_f32 v[136:137], v[136:137], v[30:31]
    v_pk_mul_f32 v[138:139], v[138:139], v[30:31]
    v_cvt_pk_bf16_f32 v136, v136, v137
    v_cvt_pk_bf16_f32 v137, v138, v139
    ds_write_b64 v24, v[136:137] offset:512
    v_pk_mul_f32 v[140:141], v[140:141], v[30:31]
    v_pk_mul_f32 v[142:143], v[142:143], v[30:31]
    v_cvt_pk_bf16_f32 v140, v140, v141
    v_cvt_pk_bf16_f32 v141, v142, v143
    ds_write_b64 v24, v[140:141] offset:8
    v_pk_mul_f32 v[144:145], v[144:145], v[30:31]
    v_pk_mul_f32 v[146:147], v[146:147], v[30:31]
    v_cvt_pk_bf16_f32 v144, v144, v145
    v_cvt_pk_bf16_f32 v145, v146, v147
    ds_write_b64 v24, v[144:145] offset:520
    v_pk_mul_f32 v[148:149], v[148:149], v[30:31]
    v_pk_mul_f32 v[150:151], v[150:151], v[30:31]
    v_cvt_pk_bf16_f32 v148, v148, v149
    v_cvt_pk_bf16_f32 v149, v150, v151
    ds_write_b64 v25, v[148:149] offset:1024
    v_pk_mul_f32 v[152:153], v[152:153], v[30:31]
    v_pk_mul_f32 v[154:155], v[154:155], v[30:31]
    v_cvt_pk_bf16_f32 v152, v152, v153
    v_cvt_pk_bf16_f32 v153, v154, v155
    ds_write_b64 v24, v[152:153] offset:256
    v_pk_mul_f32 v[156:157], v[156:157], v[30:31]
    v_pk_mul_f32 v[158:159], v[158:159], v[30:31]
    v_cvt_pk_bf16_f32 v156, v156, v157
    v_cvt_pk_bf16_f32 v157, v158, v159
    ds_write_b64 v24, v[156:157] offset:768
    v_pk_mul_f32 v[160:161], v[160:161], v[30:31]
    v_pk_mul_f32 v[162:163], v[162:163], v[30:31]
    v_cvt_pk_bf16_f32 v160, v160, v161
    v_cvt_pk_bf16_f32 v161, v162, v163
    ds_write_b64 v24, v[160:161] offset:264
    v_pk_mul_f32 v[164:165], v[164:165], v[30:31]
    v_pk_mul_f32 v[166:167], v[166:167], v[30:31]
    v_cvt_pk_bf16_f32 v164, v164, v165
    v_cvt_pk_bf16_f32 v165, v166, v167
    ds_write_b64 v24, v[164:165] offset:776
    v_pk_mul_f32 v[168:169], v[168:169], v[30:31]
    v_pk_mul_f32 v[170:171], v[170:171], v[30:31]
    v_cvt_pk_bf16_f32 v168, v168, v169
    v_cvt_pk_bf16_f32 v169, v170, v171
    ds_write_b64 v25, v[168:169] offset:1152
    v_pk_mul_f32 v[172:173], v[172:173], v[30:31]
    v_pk_mul_f32 v[174:175], v[174:175], v[30:31]
    v_cvt_pk_bf16_f32 v172, v172, v173
    v_cvt_pk_bf16_f32 v173, v174, v175
    ds_write_b64 v24, v[172:173] offset:1280
    v_pk_mul_f32 v[176:177], v[176:177], v[30:31]
    v_pk_mul_f32 v[178:179], v[178:179], v[30:31]
    v_cvt_pk_bf16_f32 v176, v176, v177
    v_cvt_pk_bf16_f32 v177, v178, v179
    ds_write_b64 v24, v[176:177] offset:1792
    v_pk_mul_f32 v[180:181], v[180:181], v[30:31]
    v_pk_mul_f32 v[182:183], v[182:183], v[30:31]
    v_cvt_pk_bf16_f32 v180, v180, v181
    v_cvt_pk_bf16_f32 v181, v182, v183
    ds_write_b64 v24, v[180:181] offset:1288
    v_pk_mul_f32 v[184:185], v[184:185], v[30:31]
    v_pk_mul_f32 v[186:187], v[186:187], v[30:31]
    v_cvt_pk_bf16_f32 v184, v184, v185
    v_cvt_pk_bf16_f32 v185, v186, v187
    ds_write_b64 v24, v[184:185] offset:1800
    v_pk_mul_f32 v[188:189], v[188:189], v[30:31]
    v_pk_mul_f32 v[190:191], v[190:191], v[30:31]
    v_cvt_pk_bf16_f32 v188, v188, v189
    v_cvt_pk_bf16_f32 v189, v190, v191
    ds_write_b64 v25, v[188:189] offset:2304
    v_pk_mul_f32 v[192:193], v[192:193], v[30:31]
    v_pk_mul_f32 v[194:195], v[194:195], v[30:31]
    v_cvt_pk_bf16_f32 v192, v192, v193
    v_cvt_pk_bf16_f32 v193, v194, v195
    ds_write_b64 v24, v[192:193] offset:1536
    v_pk_mul_f32 v[196:197], v[196:197], v[30:31]
    v_pk_mul_f32 v[198:199], v[198:199], v[30:31]
    v_cvt_pk_bf16_f32 v196, v196, v197
    v_cvt_pk_bf16_f32 v197, v198, v199
    ds_write_b64 v24, v[196:197] offset:2048
    v_pk_mul_f32 v[200:201], v[200:201], v[30:31]
    v_pk_mul_f32 v[202:203], v[202:203], v[30:31]
    v_cvt_pk_bf16_f32 v200, v200, v201
    v_cvt_pk_bf16_f32 v201, v202, v203
    ds_write_b64 v24, v[200:201] offset:1544
    v_pk_mul_f32 v[204:205], v[204:205], v[30:31]
    v_pk_mul_f32 v[206:207], v[206:207], v[30:31]
    v_cvt_pk_bf16_f32 v204, v204, v205
    v_cvt_pk_bf16_f32 v205, v206, v207
    ds_write_b64 v24, v[204:205] offset:2056
    v_pk_mul_f32 v[208:209], v[208:209], v[30:31]
    v_pk_mul_f32 v[210:211], v[210:211], v[30:31]
    v_cvt_pk_bf16_f32 v208, v208, v209
    v_cvt_pk_bf16_f32 v209, v210, v211
    ds_write_b64 v25, v[208:209] offset:2432
    v_cvt_pk_bf16_f32 v212, v212, v213
    v_cvt_pk_bf16_f32 v213, v214, v215
    ds_write_b64 v34, v[212:213]
    v_cvt_pk_bf16_f32 v216, v216, v217
    v_cvt_pk_bf16_f32 v217, v218, v219
    ds_write_b64 v35, v[216:217]
    s_branch L_stset
L_BV:
    s_lshl_b32 s23, s42, 11
    s_add_u32 s23, s23, 122880
    v_and_b32 v6, 1, v3
    v_lshrrev_b32 v7, 1, v3
    s_mul_i32 s25, s92, 672
    s_add_u32 s25, s25, s23
    v_mul_u32_u24 v8, 336, v7
    v_lshl_add_u32 v8, v6, 3, v8
    v_lshl_add_u32 v8, v2, 4, v8
    v_add_u32 v34, s25, v8
    v_cmp_lt_u32 vcc, 4, v2
    v_add_u32 v8, 256, v34
    v_mov_b32 v9, 1048576
    v_cndmask_b32 v35, v8, v9, vcc
    v_add_u32 v18, s32, v12
    v_add_u32 v20, s32, v14
    v_add_u32 v19, s32, v13
    v_add_u32 v22, s32, v16
    v_add_u32 v23, s32, v17
    v_add_u32 v21, s32, v15
    s_add_u32 s32, s32, 39424
    s_cmp_eq_u32 s32, 157696
    s_cselect_b32 s32, 0, s32
    s_barrier
    ds_read_b128 v[36:39], v18
    ds_read_b64_tr_b16 v[68:69], v20 offset:16384
    ds_read_b64_tr_b16 v[70:71], v20 offset:18944
    ds_read_b64_tr_b16 v[72:73], v20 offset:16392
    ds_read_b64_tr_b16 v[74:75], v20 offset:18952
    ds_read_b64_tr_b16 v[76:77], v20 offset:16400
    ds_read_b64_tr_b16 v[78:79], v20 offset:18960
    ds_read_b64_tr_b16 v[80:81], v20 offset:16408
    ds_read_b64_tr_b16 v[82:83], v20 offset:18968
    ds_read_b64_tr_b16 v[84:85], v20 offset:16416
    ds_read_b64_tr_b16 v[86:87], v20 offset:18976
    ds_read_b128 v[40:43], v18 offset:2048
    ds_read_b128 v[44:47], v18 offset:4096
    ds_read_b128 v[48:51], v18 offset:6144
    ds_read_b128 v[108:111], v22
    ds_read_b64_tr_b16 v[116:117], v21 offset:36864
    ds_read_b64_tr_b16 v[118:119], v21 offset:37024
    ds_read_b64_tr_b16 v[120:121], v21 offset:36896
    ds_read_b64_tr_b16 v[122:123], v21 offset:37056
    s_branch L_TV_mid
.p2align 6
L_TV_loop:
    s_barrier
    v_mfma_f32_16x16x32_bf16 v[132:135], v[88:91], v[52:55], v[132:135]
    ds_read_b128 v[36:39], v18
    v_mfma_f32_16x16x32_bf16 v[136:139], v[92:95], v[52:55], v[136:139]
    ds_read_b64_tr_b16 v[68:69], v20 offset:16384
    v_mfma_f32_16x16x32_bf16 v[140:143], v[96:99], v[52:55], v[140:143]
    ds_read_b64_tr_b16 v[70:71], v20 offset:18944
    v_mfma_f32_16x16x32_bf16 v[144:147], v[100:103], v[52:55], v[144:147]
    ds_read_b64_tr_b16 v[72:73], v20 offset:16392
    v_mfma_f32_16x16x32_bf16 v[148:151], v[104:107], v[52:55], v[148:151]
    ds_read_b64_tr_b16 v[74:75], v20 offset:18952
    v_mfma_f32_16x16x32_bf16 v[152:155], v[88:91], v[56:59], v[152:155]
    ds_read_b64_tr_b16 v[76:77], v20 offset:16400
    v_mfma_f32_16x16x32_bf16 v[156:159], v[92:95], v[56:59], v[156:159]
    ds_read_b64_tr_b16 v[78:79], v20 offset:18960
    v_mfma_f32_16x16x32_bf16 v[160:163], v[96:99], v[56:59], v[160:163]
    ds_read_b64_tr_b16 v[80:81], v20 offset:16408
    v_mfma_f32_16x16x32_bf16 v[164:167], v[100:103], v[56:59], v[164:167]
    ds_read_b64_tr_b16 v[82:83], v20 offset:18968
    v_mfma_f32_16x16x32_bf16 v[168:171], v[104:107], v[56:59], v[168:171]
    ds_read_b64_tr_b16 v[84:85], v20 offset:16416
    v_mfma_f32_16x16x32_bf16 v[172:175], v[88:91], v[60:63], v[172:175]
    ds_read_b64_tr_b16 v[86:87], v20 offset:18976
    v_mfma_f32_16x16x32_bf16 v[176:179], v[92:95], v[60:63], v[176:179]
    ds_read_b128 v[40:43], v18 offset:2048
    v_mfma_f32_16x16x32_bf16 v[180:183], v[96:99], v[60:63], v[180:183]
    ds_read_b128 v[44:47], v18 offset:4096
    v_mfma_f32_16x16x32_bf16 v[184:187], v[100:103], v[60:63], v[184:187]
    ds_read_b128 v[48:51], v18 offset:6144
    v_mfma_f32_16x16x32_bf16 v[188:191], v[104:107], v[60:63], v[188:191]
    ds_read_b128 v[108:111], v22
    v_mfma_f32_16x16x32_bf16 v[192:195], v[88:91], v[64:67], v[192:195]
    ds_read_b64_tr_b16 v[116:117], v21 offset:36864
    v_mfma_f32_16x16x32_bf16 v[196:199], v[92:95], v[64:67], v[196:199]
    ds_read_b64_tr_b16 v[118:119], v21 offset:37024
    v_mfma_f32_16x16x32_bf16 v[200:203], v[96:99], v[64:67], v[200:203]
    ds_read_b64_tr_b16 v[120:121], v21 offset:36896
    v_mfma_f32_16x16x32_bf16 v[204:207], v[100:103], v[64:67], v[204:207]
    ds_read_b64_tr_b16 v[122:123], v21 offset:37056
    v_mfma_f32_16x16x32_bf16 v[208:211], v[104:107], v[64:67], v[208:211]
    v_mfma_f32_16x16x32_bf16 v[212:215], v[112:115], v[124:127], v[212:215]
    v_mfma_f32_16x16x32_bf16 v[216:219], v[112:115], v[128:131], v[216:219]
L_TV_mid:
    s_waitcnt lgkmcnt(0)
    v_mfma_f32_16x16x32_bf16 v[132:135], v[68:71], v[36:39], v[132:135]
    ds_read_b128 v[52:55], v19
    v_mfma_f32_16x16x32_bf16 v[136:139], v[72:75], v[36:39], v[136:139]
    ds_read_b64_tr_b16 v[88:89], v20 offset:21504
    v_mfma_f32_16x16x32_bf16 v[140:143], v[76:79], v[36:39], v[140:143]
    ds_read_b64_tr_b16 v[90:91], v20 offset:24064
    v_mfma_f32_16x16x32_bf16 v[144:147], v[80:83], v[36:39], v[144:147]
    ds_read_b64_tr_b16 v[92:93], v20 offset:21512
    v_mfma_f32_16x16x32_bf16 v[148:151], v[84:87], v[36:39], v[148:151]
    ds_read_b64_tr_b16 v[94:95], v20 offset:24072
    v_mfma_f32_16x16x32_bf16 v[152:155], v[68:71], v[40:43], v[152:155]
    ds_read_b64_tr_b16 v[96:97], v20 offset:21520
    v_mfma_f32_16x16x32_bf16 v[156:159], v[72:75], v[40:43], v[156:159]
    ds_read_b64_tr_b16 v[98:99], v20 offset:24080
    v_mfma_f32_16x16x32_bf16 v[160:163], v[76:79], v[40:43], v[160:163]
    ds_read_b64_tr_b16 v[100:101], v20 offset:21528
    v_mfma_f32_16x16x32_bf16 v[164:167], v[80:83], v[40:43], v[164:167]
    ds_read_b64_tr_b16 v[102:103], v20 offset:24088
    v_mfma_f32_16x16x32_bf16 v[168:171], v[84:87], v[40:43], v[168:171]
    ds_read_b64_tr_b16 v[104:105], v20 offset:21536
    v_mfma_f32_16x16x32_bf16 v[172:175], v[68:71], v[44:47], v[172:175]
    ds_read_b64_tr_b16 v[106:107], v20 offset:24096
    v_mfma_f32_16x16x32_bf16 v[176:179], v[72:75], v[44:47], v[176:179]
    ds_read_b128 v[56:59], v19 offset:2048
    v_mfma_f32_16x16x32_bf16 v[180:183], v[76:79], v[44:47], v[180:183]
    ds_read_b128 v[60:63], v19 offset:4096
    v_mfma_f32_16x16x32_bf16 v[184:187], v[80:83], v[44:47], v[184:187]
    ds_read_b128 v[64:67], v19 offset:6144
    v_mfma_f32_16x16x32_bf16 v[188:191], v[84:87], v[44:47], v[188:191]
    ds_read_b128 v[112:115], v23
    v_mfma_f32_16x16x32_bf16 v[192:195], v[68:71], v[48:51], v[192:195]
    ds_read_b64_tr_b16 v[124:125], v21 offset:38144
    v_mfma_f32_16x16x32_bf16 v[196:199], v[72:75], v[48:51], v[196:199]
    ds_read_b64_tr_b16 v[126:127], v21 offset:38304
    v_mfma_f32_16x16x32_bf16 v[200:203], v[76:79], v[48:51], v[200:203]
    ds_read_b64_tr_b16 v[128:129], v21 offset:38176
    v_mfma_f32_16x16x32_bf16 v[204:207], v[80:83], v[48:51], v[204:207]
    ds_read_b64_tr_b16 v[130:131], v21 offset:38336
    v_mfma_f32_16x16x32_bf16 v[208:211], v[84:87], v[48:51], v[208:211]
    v_mfma_f32_16x16x32_bf16 v[212:215], v[108:111], v[116:119], v[212:215]
    v_mfma_f32_16x16x32_bf16 v[216:219], v[108:111], v[120:123], v[216:219]
    v_add_u32 v18, s32, v12
    v_add_u32 v20, s32, v14
    v_add_u32 v19, s32, v13
    v_add_u32 v22, s32, v16
    v_add_u32 v23, s32, v17
    v_add_u32 v21, s32, v15
    s_add_u32 s32, s32, 39424
    s_cmp_eq_u32 s32, 157696
    s_cselect_b32 s32, 0, s32
    s_add_u32 s27, s27, 1
    s_cmp_lt_u32 s27, 10
    s_waitcnt lgkmcnt(0)
    s_cbranch_scc1 L_TV_loop
    v_mfma_f32_16x16x32_bf16 v[132:135], v[88:91], v[52:55], v[132:135]
    v_mfma_f32_16x16x32_bf16 v[136:139], v[92:95], v[52:55], v[136:139]
    v_mfma_f32_16x16x32_bf16 v[140:143], v[96:99], v[52:55], v[140:143]
    v_mfma_f32_16x16x32_bf16 v[144:147], v[100:103], v[52:55], v[144:147]
    v_mfma_f32_16x16x32_bf16 v[148:151], v[104:107], v[52:55], v[148:151]
    v_mfma_f32_16x16x32_bf16 v[152:155], v[88:91], v[56:59], v[152:155]
    v_mfma_f32_16x16x32_bf16 v[156:159], v[92:95], v[56:59], v[156:159]
    v_mfma_f32_16x16x32_bf16 v[160:163], v[96:99], v[56:59], v[160:163]
    v_mfma_f32_16x16x32_bf16 v[164:167], v[100:103], v[56:59], v[164:167]
    v_mfma_f32_16x16x32_bf16 v[168:171], v[104:107], v[56:59], v[168:171]
    v_mfma_f32_16x16x32_bf16 v[172:175], v[88:91], v[60:63], v[172:175]
    v_mfma_f32_16x16x32_bf16 v[176:179], v[92:95], v[60:63], v[176:179]
    v_mfma_f32_16x16x32_bf16 v[180:183], v[96:99], v[60:63], v[180:183]
    v_mfma_f32_16x16x32_bf16 v[184:187], v[100:103], v[60:63], v[184:187]
    v_mfma_f32_16x16x32_bf16 v[188:191], v[104:107], v[60:63], v[188:191]
    v_mfma_f32_16x16x32_bf16 v[192:195], v[88:91], v[64:67], v[192:195]
    v_mfma_f32_16x16x32_bf16 v[196:199], v[92:95], v[64:67], v[196:199]
    v_mfma_f32_16x16x32_bf16 v[200:203], v[96:99], v[64:67], v[200:203]
    v_mfma_f32_16x16x32_bf16 v[204:207], v[100:103], v[64:67], v[204:207]
    v_mfma_f32_16x16x32_bf16 v[208:211], v[104:107], v[64:67], v[208:211]
    v_mfma_f32_16x16x32_bf16 v[212:215], v[112:115], v[124:127], v[212:215]
    v_mfma_f32_16x16x32_bf16 v[216:219], v[112:115], v[128:131], v[216:219]
    v_pk_mul_f32 v[132:133], v[132:133], v[30:31]
    v_pk_mul_f32 v[134:135], v[134:135], v[30:31]
    v_cvt_pk_bf16_f32 v132, v132, v133
    v_cvt_pk_bf16_f32 v133, v134, v135
    ds_write_b64 v24, v[132:133] offset:0
    v_pk_mul_f32 v[136:137], v[136:137], v[30:31]
    v_pk_mul_f32 v[138:139], v[138:139], v[30:31]
    v_cvt_pk_bf16_f32 v136, v136, v137
    v_cvt_pk_bf16_f32 v137, v138, v139
    ds_write_b64 v24, v[136:137] offset:512
    v_pk_mul_f32 v[140:141], v[140:141], v[30:31]
    v_pk_mul_f32 v[142:143], v[142:143], v[30:31]
    v_cvt_pk_bf16_f32 v140, v140, v141
    v_cvt_pk_bf16_f32 v141, v142, v143
    ds_write_b64 v24, v[140:141] offset:8
    v_pk_mul_f32 v[144:145], v[144:145], v[30:31]
    v_pk_mul_f32 v[146:147], v[146:147], v[30:31]
    v_cvt_pk_bf16_f32 v144, v144, v145
    v_cvt_pk_bf16_f32 v145, v146, v147
    ds_write_b64 v24, v[144:145] offset:520
    v_pk_mul_f32 v[148:149], v[148:149], v[30:31]
    v_pk_mul_f32 v[150:151], v[150:151], v[30:31]
    v_cvt_pk_bf16_f32 v148, v148, v149
    v_cvt_pk_bf16_f32 v149, v150, v151
    ds_write_b64 v25, v[148:149] offset:1024
    v_pk_mul_f32 v[152:153], v[152:153], v[30:31]
    v_pk_mul_f32 v[154:155], v[154:155], v[30:31]
    v_cvt_pk_bf16_f32 v152, v152, v153
    v_cvt_pk_bf16_f32 v153, v154, v155
    ds_write_b64 v24, v[152:153] offset:256
    v_pk_mul_f32 v[156:157], v[156:157], v[30:31]
    v_pk_mul_f32 v[158:159], v[158:159], v[30:31]
    v_cvt_pk_bf16_f32 v156, v156, v157
    v_cvt_pk_bf16_f32 v157, v158, v159
    ds_write_b64 v24, v[156:157] offset:768
    v_pk_mul_f32 v[160:161], v[160:161], v[30:31]
    v_pk_mul_f32 v[162:163], v[162:163], v[30:31]
    v_cvt_pk_bf16_f32 v160, v160, v161
    v_cvt_pk_bf16_f32 v161, v162, v163
    ds_write_b64 v24, v[160:161] offset:264
    v_pk_mul_f32 v[164:165], v[164:165], v[30:31]
    v_pk_mul_f32 v[166:167], v[166:167], v[30:31]
    v_cvt_pk_bf16_f32 v164, v164, v165
    v_cvt_pk_bf16_f32 v165, v166, v167
    ds_write_b64 v24, v[164:165] offset:776
    v_pk_mul_f32 v[168:169], v[168:169], v[30:31]
    v_pk_mul_f32 v[170:171], v[170:171], v[30:31]
    v_cvt_pk_bf16_f32 v168, v168, v169
    v_cvt_pk_bf16_f32 v169, v170, v171
    ds_write_b64 v25, v[168:169] offset:1152
    v_pk_mul_f32 v[172:173], v[172:173], v[30:31]
    v_pk_mul_f32 v[174:175], v[174:175], v[30:31]
    v_cvt_pk_bf16_f32 v172, v172, v173
    v_cvt_pk_bf16_f32 v173, v174, v175
    ds_write_b64 v24, v[172:173] offset:1280
    v_pk_mul_f32 v[176:177], v[176:177], v[30:31]
    v_pk_mul_f32 v[178:179], v[178:179], v[30:31]
    v_cvt_pk_bf16_f32 v176, v176, v177
    v_cvt_pk_bf16_f32 v177, v178, v179
    ds_write_b64 v24, v[176:177] offset:1792
    v_pk_mul_f32 v[180:181], v[180:181], v[30:31]
    v_pk_mul_f32 v[182:183], v[182:183], v[30:31]
    v_cvt_pk_bf16_f32 v180, v180, v181
    v_cvt_pk_bf16_f32 v181, v182, v183
    ds_write_b64 v24, v[180:181] offset:1288
    v_pk_mul_f32 v[184:185], v[184:185], v[30:31]
    v_pk_mul_f32 v[186:187], v[186:187], v[30:31]
    v_cvt_pk_bf16_f32 v184, v184, v185
    v_cvt_pk_bf16_f32 v185, v186, v187
    ds_write_b64 v24, v[184:185] offset:1800
    v_pk_mul_f32 v[188:189], v[188:189], v[30:31]
    v_pk_mul_f32 v[190:191], v[190:191], v[30:31]
    v_cvt_pk_bf16_f32 v188, v188, v189
    v_cvt_pk_bf16_f32 v189, v190, v191
    ds_write_b64 v25, v[188:189] offset:2304
    v_pk_mul_f32 v[192:193], v[192:193], v[30:31]
    v_pk_mul_f32 v[194:195], v[194:195], v[30:31]
    v_cvt_pk_bf16_f32 v192, v192, v193
    v_cvt_pk_bf16_f32 v193, v194, v195
    ds_write_b64 v24, v[192:193] offset:1536
    v_pk_mul_f32 v[196:197], v[196:197], v[30:31]
    v_pk_mul_f32 v[198:199], v[198:199], v[30:31]
    v_cvt_pk_bf16_f32 v196, v196, v197
    v_cvt_pk_bf16_f32 v197, v198, v199
    ds_write_b64 v24, v[196:197] offset:2048
    v_pk_mul_f32 v[200:201], v[200:201], v[30:31]
    v_pk_mul_f32 v[202:203], v[202:203], v[30:31]
    v_cvt_pk_bf16_f32 v200, v200, v201
    v_cvt_pk_bf16_f32 v201, v202, v203
    ds_write_b64 v24, v[200:201] offset:1544
    v_pk_mul_f32 v[204:205], v[204:205], v[30:31]
    v_pk_mul_f32 v[206:207], v[206:207], v[30:31]
    v_cvt_pk_bf16_f32 v204, v204, v205
    v_cvt_pk_bf16_f32 v205, v206, v207
    ds_write_b64 v24, v[204:205] offset:2056
    v_pk_mul_f32 v[208:209], v[208:209], v[30:31]
    v_pk_mul_f32 v[210:211], v[210:211], v[30:31]
    v_cvt_pk_bf16_f32 v208, v208, v209
    v_cvt_pk_bf16_f32 v209, v210, v211
    ds_write_b64 v25, v[208:209] offset:2432
    v_and_b32 v2, 15, v1
    v_cmp_eq_u32 vcc, 4, v2
    v_mov_b32 v8, 0x3f803f80
    v_cvt_pk_bf16_f32 v212, v212, v213
    v_cvt_pk_bf16_f32 v213, v214, v215
    ds_write_b64 v34, v[212:213]
    v_cvt_pk_bf16_f32 v216, v216, v217
    v_cvt_pk_bf16_f32 v217, v218, v219
    v_cndmask_b32 v216, v216, v8, vcc
    v_cndmask_b32 v217, v217, v8, vcc
    ds_write_b64 v35, v[216:217]
    s_branch L_stset
L_F:
    v_and_b32 v2, 15, v1
    v_lshrrev_b32 v3, 4, v1
    s_mul_i32 s23, s92, 21504
    s_mul_i32 s24, s42, 2688
    s_add_u32 s23, s23, s24
    s_add_u32 s23, s23, 78848
    v_lshrrev_b32 v7, 1, v3
    v_mul_u32_u24 v7, 336, v7
    v_and_b32 v8, 1, v3
    v_lshl_add_u32 v7, v8, 3, v7
    v_lshrrev_b32 v5, 2, v2
    v_mul_u32_u24 v5, 5376, v5
    v_and_b32 v6, 3, v2
    v_lshl_add_u32 v5, v6, 4, v5
    v_add3_u32 v24, v5, v7, s23
    v_add_u32 v18, s32, v12
    v_add_u32 v20, s32, v14
    v_add_u32 v19, s32, v13
    s_add_u32 s32, s32, 39424
    s_cmp_eq_u32 s32, 157696
    s_cselect_b32 s32, 0, s32
    s_barrier
    ds_read_b128 v[36:39], v18
    ds_read_b64_tr_b16 v[68:69], v20 offset:16384
    ds_read_b64_tr_b16 v[70:71], v20 offset:18944
    ds_read_b64_tr_b16 v[72:73], v20 offset:16392
    ds_read_b64_tr_b16 v[74:75], v20 offset:18952
    ds_read_b64_tr_b16 v[76:77], v20 offset:16400
    ds_read_b64_tr_b16 v[78:79], v20 offset:18960
    ds_read_b64_tr_b16 v[80:81], v20 offset:16408
    ds_read_b64_tr_b16 v[82:83], v20 offset:18968
    ds_read_b64_tr_b16 v[84:85], v20 offset:16416
    ds_read_b64_tr_b16 v[86:87], v20 offset:18976
    ds_read_b128 v[40:43], v18 offset:2048
    ds_read_b128 v[44:47], v18 offset:4096
    ds_read_b128 v[48:51], v18 offset:6144
    s_branch L_F_mid
.p2align 6
L_F_loop:
    s_barrier
    v_mfma_f32_16x16x32_bf16 v[132:135], v[52:55], v[88:91], v[132:135]
    ds_read_b128 v[36:39], v18
    v_mfma_f32_16x16x32_bf16 v[136:139], v[52:55], v[92:95], v[136:139]
    ds_read_b64_tr_b16 v[68:69], v20 offset:16384
    v_mfma_f32_16x16x32_bf16 v[140:143], v[52:55], v[96:99], v[140:143]
    ds_read_b64_tr_b16 v[70:71], v20 offset:18944
    v_mfma_f32_16x16x32_bf16 v[144:147], v[52:55], v[100:103], v[144:147]
    ds_read_b64_tr_b16 v[72:73], v20 offset:16392
    v_mfma_f32_16x16x32_bf16 v[148:151], v[52:55], v[104:107], v[148:151]
    ds_read_b64_tr_b16 v[74:75], v20 offset:18952
    v_mfma_f32_16x16x32_bf16 v[152:155], v[56:59], v[88:91], v[152:155]
    ds_read_b64_tr_b16 v[76:77], v20 offset:16400
    v_mfma_f32_16x16x32_bf16 v[156:159], v[56:59], v[92:95], v[156:159]
    ds_read_b64_tr_b16 v[78:79], v20 offset:18960
    v_mfma_f32_16x16x32_bf16 v[160:163], v[56:59], v[96:99], v[160:163]
    ds_read_b64_tr_b16 v[80:81], v20 offset:16408
    v_mfma_f32_16x16x32_bf16 v[164:167], v[56:59], v[100:103], v[164:167]
    ds_read_b64_tr_b16 v[82:83], v20 offset:18968
    v_mfma_f32_16x16x32_bf16 v[168:171], v[56:59], v[104:107], v[168:171]
    ds_read_b64_tr_b16 v[84:85], v20 offset:16416
    v_mfma_f32_16x16x32_bf16 v[172:175], v[60:63], v[88:91], v[172:175]
    ds_read_b64_tr_b16 v[86:87], v20 offset:18976
    v_mfma_f32_16x16x32_bf16 v[176:179], v[60:63], v[92:95], v[176:179]
    ds_read_b128 v[40:43], v18 offset:2048
    v_mfma_f32_16x16x32_bf16 v[180:183], v[60:63], v[96:99], v[180:183]
    ds_read_b128 v[44:47], v18 offset:4096
    v_mfma_f32_16x16x32_bf16 v[184:187], v[60:63], v[100:103], v[184:187]
    ds_read_b128 v[48:51], v18 offset:6144
    v_mfma_f32_16x16x32_bf16 v[188:191], v[60:63], v[104:107], v[188:191]
    v_mfma_f32_16x16x32_bf16 v[192:195], v[64:67], v[88:91], v[192:195]
    v_mfma_f32_16x16x32_bf16 v[196:199], v[64:67], v[92:95], v[196:199]
    v_mfma_f32_16x16x32_bf16 v[200:203], v[64:67], v[96:99], v[200:203]
    v_mfma_f32_16x16x32_bf16 v[204:207], v[64:67], v[100:103], v[204:207]
    v_mfma_f32_16x16x32_bf16 v[208:211], v[64:67], v[104:107], v[208:211]
L_F_mid:
    s_waitcnt lgkmcnt(0)
    v_mfma_f32_16x16x32_bf16 v[132:135], v[36:39], v[68:71], v[132:135]
    ds_read_b128 v[52:55], v19
    v_mfma_f32_16x16x32_bf16 v[136:139], v[36:39], v[72:75], v[136:139]
    ds_read_b64_tr_b16 v[88:89], v20 offset:21504
    v_mfma_f32_16x16x32_bf16 v[140:143], v[36:39], v[76:79], v[140:143]
    ds_read_b64_tr_b16 v[90:91], v20 offset:24064
    v_mfma_f32_16x16x32_bf16 v[144:147], v[36:39], v[80:83], v[144:147]
    ds_read_b64_tr_b16 v[92:93], v20 offset:21512
    v_mfma_f32_16x16x32_bf16 v[148:151], v[36:39], v[84:87], v[148:151]
    ds_read_b64_tr_b16 v[94:95], v20 offset:24072
    v_mfma_f32_16x16x32_bf16 v[152:155], v[40:43], v[68:71], v[152:155]
    ds_read_b64_tr_b16 v[96:97], v20 offset:21520
    v_mfma_f32_16x16x32_bf16 v[156:159], v[40:43], v[72:75], v[156:159]
    ds_read_b64_tr_b16 v[98:99], v20 offset:24080
    v_mfma_f32_16x16x32_bf16 v[160:163], v[40:43], v[76:79], v[160:163]
    ds_read_b64_tr_b16 v[100:101], v20 offset:21528
    v_mfma_f32_16x16x32_bf16 v[164:167], v[40:43], v[80:83], v[164:167]
    ds_read_b64_tr_b16 v[102:103], v20 offset:24088
    v_mfma_f32_16x16x32_bf16 v[168:171], v[40:43], v[84:87], v[168:171]
    ds_read_b64_tr_b16 v[104:105], v20 offset:21536
    v_mfma_f32_16x16x32_bf16 v[172:175], v[44:47], v[68:71], v[172:175]
    ds_read_b64_tr_b16 v[106:107], v20 offset:24096
    v_mfma_f32_16x16x32_bf16 v[176:179], v[44:47], v[72:75], v[176:179]
    ds_read_b128 v[56:59], v19 offset:2048
    v_mfma_f32_16x16x32_bf16 v[180:183], v[44:47], v[76:79], v[180:183]
    ds_read_b128 v[60:63], v19 offset:4096
    v_mfma_f32_16x16x32_bf16 v[184:187], v[44:47], v[80:83], v[184:187]
    ds_read_b128 v[64:67], v19 offset:6144
    v_mfma_f32_16x16x32_bf16 v[188:191], v[44:47], v[84:87], v[188:191]
    v_mfma_f32_16x16x32_bf16 v[192:195], v[48:51], v[68:71], v[192:195]
    v_mfma_f32_16x16x32_bf16 v[196:199], v[48:51], v[72:75], v[196:199]
    v_mfma_f32_16x16x32_bf16 v[200:203], v[48:51], v[76:79], v[200:203]
    v_mfma_f32_16x16x32_bf16 v[204:207], v[48:51], v[80:83], v[204:207]
    v_mfma_f32_16x16x32_bf16 v[208:211], v[48:51], v[84:87], v[208:211]
    v_add_u32 v18, s32, v12
    v_add_u32 v20, s32, v14
    v_add_u32 v19, s32, v13
    s_add_u32 s32, s32, 39424
    s_cmp_eq_u32 s32, 157696
    s_cselect_b32 s32, 0, s32
    s_add_u32 s27, s27, 1
    s_cmp_lt_u32 s27, 10
    s_waitcnt lgkmcnt(0)
    s_cbranch_scc1 L_F_loop
    v_mfma_f32_16x16x32_bf16 v[132:135], v[52:55], v[88:91], v[132:135]
    v_mfma_f32_16x16x32_bf16 v[136:139], v[52:55], v[92:95], v[136:139]
    v_mfma_f32_16x16x32_bf16 v[140:143], v[52:55], v[96:99], v[140:143]
    v_mfma_f32_16x16x32_bf16 v[144:147], v[52:55], v[100:103], v[144:147]
    v_mfma_f32_16x16x32_bf16 v[148:151], v[52:55], v[104:107], v[148:151]
    v_mfma_f32_16x16x32_bf16 v[152:155], v[56:59], v[88:91], v[152:155]
    v_mfma_f32_16x16x32_bf16 v[156:159], v[56:59], v[92:95], v[156:159]
    v_mfma_f32_16x16x32_bf16 v[160:163], v[56:59], v[96:99], v[160:163]
    v_mfma_f32_16x16x32_bf16 v[164:167], v[56:59], v[100:103], v[164:167]
    v_mfma_f32_16x16x32_bf16 v[168:171], v[56:59], v[104:107], v[168:171]
    v_mfma_f32_16x16x32_bf16 v[172:175], v[60:63], v[88:91], v[172:175]
    v_mfma_f32_16x16x32_bf16 v[176:179], v[60:63], v[92:95], v[176:179]
    v_mfma_f32_16x16x32_bf16 v[180:183], v[60:63], v[96:99], v[180:183]
    v_mfma_f32_16x16x32_bf16 v[184:187], v[60:63], v[100:103], v[184:187]
    v_mfma_f32_16x16x32_bf16 v[188:191], v[60:63], v[104:107], v[188:191]
    v_mfma_f32_16x16x32_bf16 v[192:195], v[64:67], v[88:91], v[192:195]
    v_mfma_f32_16x16x32_bf16 v[196:199], v[64:67], v[92:95], v[196:199]
    v_mfma_f32_16x16x32_bf16 v[200:203], v[64:67], v[96:99], v[200:203]
    v_mfma_f32_16x16x32_bf16 v[204:207], v[64:67], v[100:103], v[204:207]
    v_mfma_f32_16x16x32_bf16 v[208:211], v[64:67], v[104:107], v[208:211]
    v_cvt_pk_bf16_f32 v132, v132, v133
    v_cvt_pk_bf16_f32 v133, v134, v135
    ds_write_b64 v24, v[132:133] offset:0
    v_cvt_pk_bf16_f32 v136, v136, v137
    v_cvt_pk_bf16_f32 v137, v138, v139
    ds_write_b64 v24, v[136:137] offset:64
    v_cvt_pk_bf16_f32 v140, v140, v141
    v_cvt_pk_bf16_f32 v141, v142, v143
    ds_write_b64 v24, v[140:141] offset:128
    v_cvt_pk_bf16_f32 v144, v144, v145
    v_cvt_pk_bf16_f32 v145, v146, v147
    ds_write_b64 v24, v[144:145] offset:192
    v_cvt_pk_bf16_f32 v148, v148, v149
    v_cvt_pk_bf16_f32 v149, v150, v151
    ds_write_b64 v24, v[148:149] offset:256
    v_cvt_pk_bf16_f32 v152, v152, v153
    v_cvt_pk_bf16_f32 v153, v154, v155
    ds_write_b64 v24, v[152:153] offset:672
    v_cvt_pk_bf16_f32 v156, v156, v157
    v_cvt_pk_bf16_f32 v157, v158, v159
    ds_write_b64 v24, v[156:157] offset:736
    v_cvt_pk_bf16_f32 v160, v160, v161
    v_cvt_pk_bf16_f32 v161, v162, v163
    ds_write_b64 v24, v[160:161] offset:800
    v_cvt_pk_bf16_f32 v164, v164, v165
    v_cvt_pk_bf16_f32 v165, v166, v167
    ds_write_b64 v24, v[164:165] offset:864
    v_cvt_pk_bf16_f32 v168, v168, v169
    v_cvt_pk_bf16_f32 v169, v170, v171
    ds_write_b64 v24, v[168:169] offset:928
    v_cvt_pk_bf16_f32 v172, v172, v173
    v_cvt_pk_bf16_f32 v173, v174, v175
    ds_write_b64 v24, v[172:173] offset:1344
    v_cvt_pk_bf16_f32 v176, v176, v177
    v_cvt_pk_bf16_f32 v177, v178, v179
    ds_write_b64 v24, v[176:177] offset:1408
    v_cvt_pk_bf16_f32 v180, v180, v181
    v_cvt_pk_bf16_f32 v181, v182, v183
    ds_write_b64 v24, v[180:181] offset:1472
    v_cvt_pk_bf16_f32 v184, v184, v185
    v_cvt_pk_bf16_f32 v185, v186, v187
    ds_write_b64 v24, v[184:185] offset:1536
    v_cvt_pk_bf16_f32 v188, v188, v189
    v_cvt_pk_bf16_f32 v189, v190, v191
    ds_write_b64 v24, v[188:189] offset:1600
    v_cvt_pk_bf16_f32 v192, v192, v193
    v_cvt_pk_bf16_f32 v193, v194, v195
    ds_write_b64 v24, v[192:193] offset:2016
    v_cvt_pk_bf16_f32 v196, v196, v197
    v_cvt_pk_bf16_f32 v197, v198, v199
    ds_write_b64 v24, v[196:197] offset:2080
    v_cvt_pk_bf16_f32 v200, v200, v201
    v_cvt_pk_bf16_f32 v201, v202, v203
    ds_write_b64 v24, v[200:201] offset:2144
    v_cvt_pk_bf16_f32 v204, v204, v205
    v_cvt_pk_bf16_f32 v205, v206, v207
    ds_write_b64 v24, v[204:205] offset:2208
    v_cvt_pk_bf16_f32 v208, v208, v209
    v_cvt_pk_bf16_f32 v209, v210, v211
    ds_write_b64 v24, v[208:209] offset:2272
    s_branch L_stset
L_stset:
    s_cmp_eq_u32 s29, 2
    s_cselect_b32 s95, 1, 0
    s_cselect_b32 s26, 1280, 0
    s_cmp_eq_u32 s29, 1
    s_cselect_b32 s23, 1, s95
    s_cmp_eq_u32 s23, 1
    s_mov_b32 s33, 82048
    s_cmov_b32 s33, 168064
    s_mov_b32 s94, 1280
    s_cmov_b32 s94, 2624
    s_mov_b32 s23, 5546112
    s_cmov_b32 s23, 0
    s_add_u32 s23, s23, s26
    s_cmp_eq_u32 s29, 3
    s_cselect_b32 s24, 32, 0
    s_lshl_b32 s25, s30, 3
    s_add_u32 s24, s24, s25
    s_add_u32 s24, s24, s20
    s_mul_i32 s24, s24, s33
    s_add_u32 s23, s23, s24
    s_lshl_b32 s24, s94, 2
    s_mul_i32 s25, s24, s28
    s_add_u32 s23, s23, s25
    s_sub_u32 s24, s24, s26
    s_add_u32 s8, s84, s23
    s_addc_u32 s9, s85, 0
    s_mov_b32 s10, s24
    s_mov_b32 s11, 0x00020000
    s_cmp_eq_u32 s95, 1
    s_mov_b32 s95, 80
    s_cmov_b32 s95, 84
    s_mov_b32 s23, 820
    s_cmov_b32 s23, 781
    s_lshl_b32 s25, s95, 4
    s_sub_u32 s25, s94, s25
    v_add_u32 v2, 0, v1
    v_mul_u32_u24 v3, s23, v2
    v_lshrrev_b32 v3, 16, v3
    v_lshlrev_b32 v2, 4, v2
    v_mad_u32_u24 v220, v3, s25, v2
    v_add_u32 v2, 64, v1
    v_mul_u32_u24 v3, s23, v2
    v_lshrrev_b32 v3, 16, v3
    v_lshlrev_b32 v2, 4, v2
    v_mad_u32_u24 v221, v3, s25, v2
    v_add_u32 v2, 128, v1
    v_mul_u32_u24 v3, s23, v2
    v_lshrrev_b32 v3, 16, v3
    v_lshlrev_b32 v2, 4, v2
    v_mad_u32_u24 v222, v3, s25, v2
    v_add_u32 v2, 192, v1
    v_mul_u32_u24 v3, s23, v2
    v_lshrrev_b32 v3, 16, v3
    v_lshlrev_b32 v2, 4, v2
    v_mad_u32_u24 v223, v3, s25, v2
    v_add_u32 v2, 256, v1
    v_mul_u32_u24 v3, s23, v2
    v_lshrrev_b32 v3, 16, v3
    v_lshlrev_b32 v2, 4, v2
    v_mad_u32_u24 v224, v3, s25, v2
    v_add_u32 v2, 320, v1
    v_mul_u32_u24 v3, s23, v2
    v_lshrrev_b32 v3, 16, v3
    v_lshlrev_b32 v2, 4, v2
    v_mad_u32_u24 v225, v3, s25, v2
    s_lshl_b32 s39, s29, 2
    s_add_u32 s39, s39, s30
    s_lshl_b32 s39, s39, 4
    s_add_u32 s39, s39, s28
    s_lshl_b32 s39, s39, 3
    s_add_u32 s39, s39, 16040576
L_stgo:
    s_mul_i32 s23, s20, 5376
    s_add_u32 s23, s23, 78848
    v_lshl_add_u32 v2, v1, 4, s23
    s_waitcnt lgkmcnt(0)
    s_barrier
    v_mov_b32 v3, 163808
    ds_read_b64 v[10:11], v3
    s_cmp_lg_u32 s29, 3
    s_cbranch_scc1 L_noe
    s_cmp_eq_u32 s38, 0
    s_cbranch_scc1 L_noe
    s_lshl_b32 s23, s22, 10
    s_add_u32 s23, s23, 122880
    v_lshl_add_u32 v3, v1, 4, s23
    ds_read_b128 v[56:59], v3
    s_and_b32 s24, s22, 2
    s_and_b32 s25, s30, 1
    s_add_u32 s24, s24, s25
    s_lshl_b32 s25, s28, 2
    s_add_u32 s24, s24, s25
    s_mul_i32 s24, s24, 2624
    s_add_u32 s24, s24, 5378048
    s_cmp_lt_u32 s30, 2
    s_cselect_b32 s25, 0, 1280
    s_mov_b32 s26, 1344
    s_cmov_b32 s26, 1280
    s_add_u32 s24, s24, s25
    s_add_u32 s12, s84, s24
    s_addc_u32 s13, s85, 0
    s_mov_b32 s14, s26
    s_mov_b32 s15, 0x00020000
    s_and_b32 s23, s22, 1
    s_lshl_b32 s23, s23, 10
    v_lshl_add_u32 v3, v1, 4, s23
    s_waitcnt lgkmcnt(0)
    buffer_store_dwordx4 v[56:59], v3, s[12:15], 0 offen sc1
L_noe:
    ds_read_b128 v[36:39], v2 offset:0
    ds_read_b128 v[40:43], v2 offset:1024
    ds_read_b128 v[44:47], v2 offset:2048
    ds_read_b128 v[48:51], v2 offset:3072
    ds_read_b128 v[52:55], v2 offset:4096
    s_waitcnt lgkmcnt(4)
    buffer_store_dwordx4 v[36:39], v220, s[8:11], 0 offen sc1
    s_waitcnt lgkmcnt(3)
    buffer_store_dwordx4 v[40:43], v221, s[8:11], 0 offen sc1
    s_waitcnt lgkmcnt(2)
    buffer_store_dwordx4 v[44:47], v222, s[8:11], 0 offen sc1
    s_waitcnt lgkmcnt(1)
    buffer_store_dwordx4 v[48:51], v223, s[8:11], 0 offen sc1
    s_waitcnt lgkmcnt(0)
    buffer_store_dwordx4 v[52:55], v224, s[8:11], 0 offen sc1
    s_cmp_lg_u32 s29, 2
    s_cbranch_scc1 L_no6
    ds_read_b128 v[56:59], v2 offset:5120
    s_waitcnt lgkmcnt(0)
    buffer_store_dwordx4 v[56:59], v225, s[8:11], 0 offen sc1
L_no6:
    v_add_u32 v2, 0, v1
    v_mul_u32_u24 v3, 6554, v2
    v_lshrrev_b32 v3, 16, v3
    v_mul_u32_u24 v4, 10, v3
    v_sub_u32 v4, v2, v4
    v_lshrrev_b32 v6, 4, v3
    v_and_b32 v7, 3, v3
    v_bfe_u32 v8, v3, 3, 1
    v_mul_u32_u24 v8, 20, v8
    v_and_b32 v9, 4, v3
    v_add3_u32 v8, v8, v9, v7
    v_lshl_add_u32 v8, v6, 3, v8
    v_mul_u32_u24 v8, 1280, v8
    v_lshl_add_u32 v196, v4, 4, v8
    v_lshrrev_b32 v8, 2, v3
    v_mul_u32_u24 v8, 20, v8
    v_add3_u32 v8, v8, v7, 16
    v_mul_u32_u24 v8, 1280, v8
    v_lshl_add_u32 v201, v4, 4, v8
    v_add_u32 v2, 64, v1
    v_mul_u32_u24 v3, 6554, v2
    v_lshrrev_b32 v3, 16, v3
    v_mul_u32_u24 v4, 10, v3
    v_sub_u32 v4, v2, v4
    v_lshrrev_b32 v6, 4, v3
    v_and_b32 v7, 3, v3
    v_bfe_u32 v8, v3, 3, 1
    v_mul_u32_u24 v8, 20, v8
    v_and_b32 v9, 4, v3
    v_add3_u32 v8, v8, v9, v7
    v_lshl_add_u32 v8, v6, 3, v8
    v_mul_u32_u24 v8, 1280, v8
    v_lshl_add_u32 v197, v4, 4, v8
    v_lshrrev_b32 v8, 2, v3
    v_mul_u32_u24 v8, 20, v8
    v_add3_u32 v8, v8, v7, 16
    v_mul_u32_u24 v8, 1280, v8
    v_lshl_add_u32 v202, v4, 4, v8
    v_add_u32 v2, 128, v1
    v_mul_u32_u24 v3, 6554, v2
    v_lshrrev_b32 v3, 16, v3
    v_mul_u32_u24 v4, 10, v3
    v_sub_u32 v4, v2, v4
    v_lshrrev_b32 v6, 4, v3
    v_and_b32 v7, 3, v3
    v_bfe_u32 v8, v3, 3, 1
    v_mul_u32_u24 v8, 20, v8
    v_and_b32 v9, 4, v3
    v_add3_u32 v8, v8, v9, v7
    v_lshl_add_u32 v8, v6, 3, v8
    v_mul_u32_u24 v8, 1280, v8
    v_lshl_add_u32 v198, v4, 4, v8
    v_lshrrev_b32 v8, 2, v3
    v_mul_u32_u24 v8, 20, v8
    v_add3_u32 v8, v8, v7, 16
    v_mul_u32_u24 v8, 1280, v8
    v_lshl_add_u32 v203, v4, 4, v8
    v_add_u32 v2, 192, v1
    v_mul_u32_u24 v3, 6554, v2
    v_lshrrev_b32 v3, 16, v3
    v_mul_u32_u24 v4, 10, v3
    v_sub_u32 v4, v2, v4
    v_lshrrev_b32 v6, 4, v3
    v_and_b32 v7, 3, v3
    v_bfe_u32 v8, v3, 3, 1
    v_mul_u32_u24 v8, 20, v8
    v_and_b32 v9, 4, v3
    v_add3_u32 v8, v8, v9, v7
    v_lshl_add_u32 v8, v6, 3, v8
    v_mul_u32_u24 v8, 1280, v8
    v_lshl_add_u32 v199, v4, 4, v8
    v_lshrrev_b32 v8, 2, v3
    v_mul_u32_u24 v8, 20, v8
    v_add3_u32 v8, v8, v7, 16
    v_mul_u32_u24 v8, 1280, v8
    v_lshl_add_u32 v204, v4, 4, v8
    v_add_u32 v2, 256, v1
    v_mul_u32_u24 v3, 6554, v2
    v_lshrrev_b32 v3, 16, v3
    v_mul_u32_u24 v4, 10, v3
    v_sub_u32 v4, v2, v4
    v_lshrrev_b32 v6, 4, v3
    v_and_b32 v7, 3, v3
    v_bfe_u32 v8, v3, 3, 1
    v_mul_u32_u24 v8, 20, v8
    v_and_b32 v9, 4, v3
    v_add3_u32 v8, v8, v9, v7
    v_lshl_add_u32 v8, v6, 3, v8
    v_mul_u32_u24 v8, 1280, v8
    v_lshl_add_u32 v200, v4, 4, v8
    v_lshrrev_b32 v8, 2, v3
    v_mul_u32_u24 v8, 20, v8
    v_add3_u32 v8, v8, v7, 16
    v_mul_u32_u24 v8, 1280, v8
    v_lshl_add_u32 v205, v4, 4, v8
    s_and_b32 s23, s2, 7
    s_lshr_b32 s24, s2, 3
    s_lshr_b32 s37, s23, 2
    s_and_b32 s23, s23, 3
    s_lshl_b32 s23, s23, 2
    s_and_b32 s25, s24, 3
    s_add_u32 s23, s23, s25
    s_lshr_b32 s34, s24, 2
    s_lshl_b32 s40, s23, 7
    s_lshl_b32 s23, s20, 4
    s_add_u32 s40, s40, s23
    v_and_b32 v6, 15, v1
    v_lshrrev_b32 v3, 4, v1
    v_add_u32 v7, s40, v6
    v_lshlrev_b32 v206, 15, v3
    v_lshl_add_u32 v206, v7, 4, v206
    v_lshlrev_b32 v207, 14, v3
    v_lshl_add_u32 v207, v7, 3, v207
    v_lshrrev_b32 v8, 2, v1
    v_mul_u32_u24 v8, 160, v8
    v_and_b32 v9, 3, v1
    v_lshl_add_u32 v210, v9, 3, v8
    v_add_u32 v210, 10496, v210
    v_mul_u32_u24 v6, 2560, v6
    v_lshl_add_u32 v213, v3, 3, v6
    v_and_b32 v8, 1, v3
    v_lshl_add_u32 v8, v8, 5, v6
    v_lshrrev_b32 v3, 1, v3
    v_lshl_add_u32 v212, v3, 4, v8
    s_lshl_b32 s23, s34, 11
    s_lshl_b32 s24, s37, 10
    s_add_u32 s23, s23, s24
    s_lshr_b32 s24, s40, 9
    s_lshl_b32 s24, s24, 8
    s_add_u32 s23, s23, s24
    s_add_u32 s23, s23, 16171648
    v_and_b32 v208, 31, v1
    v_lshl_add_u32 v208, v208, 3, s23
    s_cmp_eq_u32 s37, 0
    s_cselect_b32 s23, s68, s78
    s_cselect_b32 s24, s69, s79
    s_mul_i32 s25, s34, 160
    s_add_u32 s92, s23, s25
    s_addc_u32 s93, s24, 0
    s_sub_u32 s94, 819200, s25
    s_mov_b32 s95, 0x00020000
    s_and_b32 s23, s2, 7
    s_lshr_b32 s24, s2, 3
    s_lshr_b32 s30, s24, 4
    s_bfe_u32 s25, s24, 0x20002
    s_lshl_b32 s28, s23, 2
    s_add_u32 s28, s28, s25
    s_and_b32 s26, s24, 3
    s_lshl_b32 s29, s26, 9
    s_lshl_b32 s24, s20, 6
    s_add_u32 s29, s29, s24
    v_and_b32 v2, 31, v1
    v_lshrrev_b32 v3, 5, v1
    v_lshlrev_b32 v12, 4, v1
    v_lshlrev_b32 v19, 4, v1
    v_lshlrev_b32 v14, 3, v2
    v_lshl_add_u32 v14, v3, 2, v14
    v_cmp_eq_u32 vcc, 24, v2
    v_mov_b32 v5, 20
    v_mov_b32 v6, 1048576
    v_cndmask_b32 v4, v2, v5, vcc
    v_mul_u32_u24 v16, 336, v3
    v_lshl_add_u32 v16, v4, 4, v16
    v_cmp_lt_u32 vcc, 20, v4
    v_mov_b32 v18, 0xdddddddd
    v_mov_b32 v81, 0x3f80
    v_cndmask_b32 v16, v16, v6, vcc
    v_cmp_eq_u32 vcc, 20, v2
    v_mov_b32 v83, 0x3f80
    v_mov_b32 v69, 0
    v_cndmask_b32 v16, v16, v6, vcc
    v_mov_b32 v71, 0
    v_add_u32 v13, 31488, v12
    v_add_u32 v15, 31488, v14
    v_add_u32 v17, 31488, v16
    s_mul_i32 s24, s30, 2621696
    s_add_u32 s24, s24, 10797184
    s_add_u32 s16, s84, s24
    s_addc_u32 s17, s85, 0
    s_mov_b32 s18, 2621696
    s_mov_b32 s19, 0x00020000
    s_lshl_b32 s25, s28, 16
    s_lshl_b32 s24, s29, 4
    s_add_u32 s25, s25, s24
    v_lshlrev_b32 v22, 15, v3
    v_lshl_add_u32 v22, v2, 4, v22
    v_add_u32 v22, s25, v22
    s_lshl_b32 s25, s28, 14
    s_lshl_b32 s24, s29, 3
    s_add_u32 s25, s25, s24
    s_add_u32 s25, s25, 2097280
    v_lshlrev_b32 v23, 3, v2
    v_lshl_add_u32 v23, v3, 24, v23
    v_add_u32 v23, s25, v23
    s_lshl_b32 s32, s30, 10
    s_lshl_b32 s24, s26, 8
    s_add_u32 s32, s32, s24
    s_lshl_b32 s24, s28, 3
    s_add_u32 s32, s32, s24
    s_add_u32 s32, s32, 16171648
    s_lshr_b32 s24, s28, 3
    s_lshl_b32 s24, s24, 7
    v_and_b32 v4, 15, v1
    v_lshrrev_b32 v5, 4, v1
    v_add_u32 v5, 1, v5
    v_lshlrev_b32 v5, 9, v5
    v_lshl_add_u32 v5, v4, 3, v5
    v_and_b32 v4, 3, v1
    s_lshl_b32 s25, s26, 5
    v_lshl_add_u32 v4, v4, 3, s25
    v_cmp_gt_u32 vcc, 32, v1
    v_lshlrev_b32 v6, 3, v1
    v_add_u32 v6, 1536, v6
    v_cndmask_b32 v7, v4, v5, vcc
    v_add_u32 v7, s24, v7
    s_cmp_eq_u32 s30, 0
    s_cselect_b64 vcc, -1, 0
    s_and_b32 s24, s2, 7
    s_lshl_b32 s24, s24, 11
    s_add_u32 s24, s24, 16040576
    v_cndmask_b32 v7, v6, v7, vcc
    v_add_u32 v7, s24, v7
    v_mov_b32 v164, 0
    v_mov_b32 v165, 0
    v_mov_b32 v166, 0
    v_mov_b32 v167, 0
    v_mov_b32 v168, 0
    v_mov_b32 v169, 0
    v_mov_b32 v170, 0
    v_mov_b32 v171, 0
    v_mov_b32 v172, 0
    v_mov_b32 v173, 0
    v_mov_b32 v174, 0
    v_mov_b32 v175, 0
    v_mov_b32 v176, 0
    v_mov_b32 v177, 0
    v_mov_b32 v178, 0
    v_mov_b32 v179, 0
    v_mov_b32 v180, 0
    v_mov_b32 v181, 0
    v_mov_b32 v182, 0
    v_mov_b32 v183, 0
    v_mov_b32 v184, 0
    v_mov_b32 v185, 0
    v_mov_b32 v186, 0
    v_mov_b32 v187, 0
    v_mov_b32 v188, 0
    v_mov_b32 v189, 0
    v_mov_b32 v190, 0
    v_mov_b32 v191, 0
    v_mov_b32 v192, 0
    v_mov_b32 v193, 0
    v_mov_b32 v194, 0
    v_mov_b32 v195, 0
    v_mov_b32 v156, 0
    v_mov_b32 v157, 0
    v_mov_b32 v158, 0
    v_mov_b32 v159, 0
    v_mov_b32 v160, 0
    v_mov_b32 v161, 0
    v_mov_b32 v162, 0
    v_mov_b32 v163, 0
    v_mov_b32 v96, 0
    v_mov_b32 v97, 0
    v_mov_b32 v98, 0
    v_mov_b32 v99, 0
    s_cmp_eq_u32 s30, 0
    s_cselect_b32 s24, s28, 32
    s_mul_i32 s24, s24, 168064
    s_lshl_b32 s25, s30, 5
    s_add_u32 s25, s25, s28
    s_mul_i32 s25, s25, 82048
    s_mul_i32 s26, s29, 40
    s_add_u32 s25, s25, s26
    s_add_u32 s25, s25, 5546112
    v_readfirstlane_b32 s86, v10
    v_readfirstlane_b32 s87, v11
    s_waitcnt vmcnt(0)
    s_add_u32 s8, s84, s24
    s_addc_u32 s9, s85, 0
    s_mov_b32 s10, 167936
    s_mov_b32 s11, 0x00020000
    s_add_u32 s12, s84, s25
    s_addc_u32 s13, s85, 0
    s_mov_b32 s14, 2560
    s_mov_b32 s15, 0x00020000
    s_barrier
    s_cmp_lg_u32 s20, 0
    s_cbranch_scc1 L_f1w
    v_lshl_add_u32 v2, v1, 11, s39
    v_mov_b32 v4, s86
    v_mov_b32 v5, s87
    s_mov_b32 exec_lo, 255
    s_mov_b32 exec_hi, 0
    global_store_dwordx2 v2, v[4:5], s[84:85] sc1
    s_mov_b64 exec, -1
    s_mov_b32 s43, 1000000
L_f1l:
    global_load_dwordx2 v[10:11], v7, s[84:85] sc1
    s_waitcnt vmcnt(0)
    v_cmp_ne_u64 vcc, s[86:87], v[10:11]
    s_sub_u32 s43, s43, 1
    s_cbranch_scc1 L_f1w
    s_cbranch_vccnz L_f1l
L_f1w:
    s_barrier
    s_lshl_b32 s31, s20, 10
    s_mov_b32 m0, s31
    s_nop 0
    buffer_load_dwordx4 v19, s[8:11], s31 offen sc1 lds
    s_add_u32 s31, s31, 8192
    buffer_load_dwordx4 v[60:63], v12, s[12:15], 0 offen offset:0 sc1
    buffer_load_dword v68, v14, s[12:15], 0 offen offset:1024 sc1
    buffer_load_dwordx4 v[64:67], v12, s[12:15], 0 offen offset:1280 sc1
    buffer_load_dword v70, v14, s[12:15], 0 offen offset:2304 sc1
    s_mov_b32 m0, s31
    s_nop 0
    buffer_load_dwordx4 v19, s[8:11], s31 offen sc1 lds
    s_add_u32 s31, s31, 8192
    s_waitcnt vmcnt(1)
    s_barrier
    ds_read_b128 v[72:75], v12
    ds_read_b32 v80, v14 offset:1024
    ds_read_b128 v[76:79], v12 offset:2624
    ds_read_b32 v82, v14 offset:3648
    ds_read_b128 v[84:87], v16 offset:1280
    ds_read_b128 v[88:91], v16 offset:1952
    s_waitcnt lgkmcnt(4)
    v_mfma_f32_32x32x16_bf16 v[100:115], v[72:75], v[60:63], 0
    v_mfma_f32_32x32x8_bf16 v[100:115], v[80:81], v[68:69], v[100:115]
    v_mfma_f32_32x32x16_bf16 v[132:147], v[72:75], v[64:67], 0
    v_mfma_f32_32x32x8_bf16 v[132:147], v[80:81], v[70:71], v[132:147]
    v_cmp_gt_u32 vcc, 32, v1
    s_mov_b32 m0, s31
    s_nop 0
    buffer_load_dwordx4 v19, s[8:11], s31 offen sc1 lds
    s_add_u32 s31, s31, 8192
    s_mov_b32 m0, s31
    s_nop 0
    buffer_load_dwordx4 v19, s[8:11], s31 offen sc1 lds
    s_add_u32 s31, s31, 8192
    s_nop 0
    v_max3_f32 v20, v100, v101, v102
    v_max3_f32 v20, v103, v104, v20
    v_max3_f32 v20, v105, v106, v20
    v_max3_f32 v20, v107, v108, v20
    v_max3_f32 v20, v109, v110, v20
    v_max3_f32 v20, v111, v112, v20
    v_max3_f32 v20, v113, v114, v20
    v_max_f32 v20, v115, v20
    v_max3_f32 v21, v132, v133, v134
    v_max3_f32 v21, v135, v136, v21
    v_max3_f32 v21, v137, v138, v21
    v_max3_f32 v21, v139, v140, v21
    v_max3_f32 v21, v141, v142, v21
    v_max3_f32 v21, v143, v144, v21
    v_max3_f32 v21, v145, v146, v21
    v_max_f32 v21, v147, v21
    v_mov_b32 v2, v20
    v_mov_b32 v3, v21
    s_nop 1
    v_permlane32_swap_b32 v2, v20
    v_permlane32_swap_b32 v3, v21
    s_nop 1
    v_max_f32 v20, v20, v2
    v_max_f32 v21, v21, v3
    v_sub_f32 v4, 0, v20
    v_and_b32 v5, 0xffff0000, v4
    v_sub_f32 v6, v4, v5
    v_and_b32 v6, 0xffff0000, v6
    v_cndmask_b32 v7, v6, v5, vcc
    v_lshrrev_b32 v69, 16, v7
    v_add_f32 v24, v5, v6
    v_add_f32 v25, v5, v6
    v_sub_f32 v4, 0, v21
    v_and_b32 v5, 0xffff0000, v4
    v_sub_f32 v6, v4, v5
    v_and_b32 v6, 0xffff0000, v6
    v_cndmask_b32 v7, v6, v5, vcc
    v_lshrrev_b32 v71, 16, v7
    v_add_f32 v26, v5, v6
    v_add_f32 v27, v5, v6
    v_pk_add_f32 v[100:101], v[100:101], v[24:25]
    v_pk_add_f32 v[102:103], v[102:103], v[24:25]
    v_pk_add_f32 v[104:105], v[104:105], v[24:25]
    v_pk_add_f32 v[106:107], v[106:107], v[24:25]
    v_pk_add_f32 v[108:109], v[108:109], v[24:25]
    v_pk_add_f32 v[110:111], v[110:111], v[24:25]
    v_pk_add_f32 v[112:113], v[112:113], v[24:25]
    v_pk_add_f32 v[114:115], v[114:115], v[24:25]
    v_pk_add_f32 v[132:133], v[132:133], v[26:27]
    v_pk_add_f32 v[134:135], v[134:135], v[26:27]
    v_pk_add_f32 v[136:137], v[136:137], v[26:27]
    v_pk_add_f32 v[138:139], v[138:139], v[26:27]
    v_pk_add_f32 v[140:141], v[140:141], v[26:27]
    v_pk_add_f32 v[142:143], v[142:143], v[26:27]
    v_pk_add_f32 v[144:145], v[144:145], v[26:27]
    v_pk_add_f32 v[146:147], v[146:147], v[26:27]
    s_mov_b32 s27, 0
    s_setprio 1
    s_waitcnt vmcnt(2) lgkmcnt(0)
    s_barrier
.p2align 6
    v_exp_f32 v100, v100
    v_exp_f32 v101, v101
    v_smfmac_f32_32x32x32_bf16 v[180:195], v[96:99], v[156:163], v18
    s_mov_b32 m0, s31
    ds_read_b128 v[92:95], v16 offset:3904
    v_exp_f32 v102, v102
    v_exp_f32 v103, v103
    v_exp_f32 v104, v104
    v_exp_f32 v105, v105
    v_mfma_f32_32x32x16_bf16 v[116:131], v[76:79], v[60:63], 0
    ds_read_b128 v[72:75], v12 offset:5248
    v_exp_f32 v106, v106
    v_exp_f32 v107, v107
    v_exp_f32 v108, v108
    v_exp_f32 v109, v109
    v_smfmac_f32_32x32x32_bf16 v[164:179], v[84:87], v[100:107], v18
    s_waitcnt lgkmcnt(2)
    ds_read_b32 v80, v14 offset:6272
    v_exp_f32 v110, v110
    v_exp_f32 v111, v111
    v_exp_f32 v112, v112
    v_exp_f32 v113, v113
    v_mfma_f32_32x32x8_bf16 v[116:131], v[82:83], v[68:69], v[116:131]
    buffer_load_dwordx4 v19, s[8:11], s31 offen sc1 lds
    s_add_u32 s26, s31, 8192
    v_exp_f32 v114, v114
    v_exp_f32 v115, v115
    v_exp_f32 v132, v132
    v_exp_f32 v133, v133
    v_smfmac_f32_32x32x32_bf16 v[164:179], v[88:91], v[108:115], v18
    s_add_u32 m0, s31, 8192
    ds_read_b128 v[96:99], v16 offset:4576
    v_exp_f32 v134, v134
    v_exp_f32 v135, v135
    v_exp_f32 v136, v136
    v_exp_f32 v137, v137
    v_mfma_f32_32x32x16_bf16 v[148:163], v[76:79], v[64:67], 0
    buffer_load_dwordx4 v19, s[8:11], s26 offen sc1 lds
    v_exp_f32 v138, v138
    v_exp_f32 v139, v139
    v_exp_f32 v140, v140
    v_exp_f32 v141, v141
    v_smfmac_f32_32x32x32_bf16 v[180:195], v[84:87], v[132:139], v18
    s_add_u32 s31, s31, 16384
    s_waitcnt lgkmcnt(1)
    v_exp_f32 v142, v142
    v_exp_f32 v143, v143
    v_exp_f32 v144, v144
    v_exp_f32 v145, v145
    v_mfma_f32_32x32x8_bf16 v[148:163], v[82:83], v[70:71], v[148:163]
    v_exp_f32 v146, v146
    v_exp_f32 v147, v147
    v_exp_f32 v116, v116
    v_exp_f32 v117, v117
    v_smfmac_f32_32x32x32_bf16 v[180:195], v[88:91], v[140:147], v18
    s_mov_b32 m0, s31
    ds_read_b128 v[84:87], v16 offset:6528
    v_exp_f32 v118, v118
    v_exp_f32 v119, v119
    v_exp_f32 v120, v120
    v_exp_f32 v121, v121
    v_mfma_f32_32x32x16_bf16 v[100:115], v[72:75], v[60:63], 0
    ds_read_b128 v[76:79], v12 offset:7872
    v_exp_f32 v122, v122
    v_exp_f32 v123, v123
    v_exp_f32 v124, v124
    v_exp_f32 v125, v125
    v_smfmac_f32_32x32x32_bf16 v[164:179], v[92:95], v[116:123], v18
    s_waitcnt lgkmcnt(2)
    ds_read_b32 v82, v14 offset:8896
    v_exp_f32 v126, v126
    v_exp_f32 v127, v127
    v_exp_f32 v128, v128
    v_exp_f32 v129, v129
    v_mfma_f32_32x32x8_bf16 v[100:115], v[80:81], v[68:69], v[100:115]
    buffer_load_dwordx4 v19, s[8:11], s31 offen sc1 lds
    s_add_u32 s26, s31, 8192
    v_exp_f32 v130, v130
    v_exp_f32 v131, v131
    v_exp_f32 v148, v148
    v_exp_f32 v149, v149
    v_smfmac_f32_32x32x32_bf16 v[164:179], v[96:99], v[124:131], v18
    s_add_u32 m0, s31, 8192
    ds_read_b128 v[88:91], v16 offset:7200
    v_exp_f32 v150, v150
    v_exp_f32 v151, v151
    v_exp_f32 v152, v152
    v_exp_f32 v153, v153
    v_mfma_f32_32x32x16_bf16 v[132:147], v[72:75], v[64:67], 0
    buffer_load_dwordx4 v19, s[8:11], s26 offen sc1 lds
    v_exp_f32 v154, v154
    v_exp_f32 v155, v155
    v_exp_f32 v156, v156
    v_exp_f32 v157, v157
    v_smfmac_f32_32x32x32_bf16 v[180:195], v[92:95], v[148:155], v18
    s_add_u32 s31, s31, 16384
    s_waitcnt lgkmcnt(1)
    v_exp_f32 v158, v158
    v_exp_f32 v159, v159
    v_exp_f32 v160, v160
    v_exp_f32 v161, v161
    v_mfma_f32_32x32x8_bf16 v[132:147], v[80:81], v[70:71], v[132:147]
    v_exp_f32 v162, v162
    v_exp_f32 v163, v163
    v_exp_f32 v100, v100
    v_exp_f32 v101, v101
    v_smfmac_f32_32x32x32_bf16 v[180:195], v[96:99], v[156:163], v18
    s_mov_b32 m0, s31
    ds_read_b128 v[92:95], v16 offset:9152
    v_exp_f32 v102, v102
    v_exp_f32 v103, v103
    v_exp_f32 v104, v104
    v_exp_f32 v105, v105
    v_mfma_f32_32x32x16_bf16 v[116:131], v[76:79], v[60:63], 0
    ds_read_b128 v[72:75], v12 offset:10496
    v_exp_f32 v106, v106
    v_exp_f32 v107, v107
    v_exp_f32 v108, v108
    v_exp_f32 v109, v109
    v_smfmac_f32_32x32x32_bf16 v[164:179], v[84:87], v[100:107], v18
    s_waitcnt lgkmcnt(2)
    ds_read_b32 v80, v14 offset:11520
    v_exp_f32 v110, v110
    v_exp_f32 v111, v111
    v_exp_f32 v112, v112
    v_exp_f32 v113, v113
    v_mfma_f32_32x32x8_bf16 v[116:131], v[82:83], v[68:69], v[116:131]
    buffer_load_dwordx4 v19, s[8:11], s31 offen sc1 lds
    s_add_u32 s26, s31, 8192
    v_exp_f32 v114, v114
    v_exp_f32 v115, v115
    v_exp_f32 v132, v132
    v_exp_f32 v133, v133
    v_smfmac_f32_32x32x32_bf16 v[164:179], v[88:91], v[108:115], v18
    s_add_u32 m0, s31, 8192
    ds_read_b128 v[96:99], v16 offset:9824
    v_exp_f32 v134, v134
    v_exp_f32 v135, v135
    v_exp_f32 v136, v136
    v_exp_f32 v137, v137
    v_mfma_f32_32x32x16_bf16 v[148:163], v[76:79], v[64:67], 0
    buffer_load_dwordx4 v19, s[8:11], s26 offen sc1 lds
    v_exp_f32 v138, v138
    v_exp_f32 v139, v139
    v_exp_f32 v140, v140
    v_exp_f32 v141, v141
    v_smfmac_f32_32x32x32_bf16 v[180:195], v[84:87], v[132:139], v18
    s_add_u32 s31, s31, 16384
    s_waitcnt lgkmcnt(1)
    v_exp_f32 v142, v142
    v_exp_f32 v143, v143
    v_exp_f32 v144, v144
    v_exp_f32 v145, v145
    v_mfma_f32_32x32x8_bf16 v[148:163], v[82:83], v[70:71], v[148:163]
    v_exp_f32 v146, v146
    v_exp_f32 v147, v147
    v_exp_f32 v116, v116
    v_exp_f32 v117, v117
    v_smfmac_f32_32x32x32_bf16 v[180:195], v[88:91], v[140:147], v18
    s_mov_b32 m0, s31
    ds_read_b128 v[84:87], v16 offset:11776
    v_exp_f32 v118, v118
    v_exp_f32 v119, v119
    v_exp_f32 v120, v120
    v_exp_f32 v121, v121
    v_mfma_f32_32x32x16_bf16 v[100:115], v[72:75], v[60:63], 0
    ds_read_b128 v[76:79], v12 offset:13120
    v_exp_f32 v122, v122
    v_exp_f32 v123, v123
    v_exp_f32 v124, v124
    v_exp_f32 v125, v125
    v_smfmac_f32_32x32x32_bf16 v[164:179], v[92:95], v[116:123], v18
    s_waitcnt lgkmcnt(2)
    ds_read_b32 v82, v14 offset:14144
    v_exp_f32 v126, v126
    v_exp_f32 v127, v127
    v_exp_f32 v128, v128
    v_exp_f32 v129, v129
    v_mfma_f32_32x32x8_bf16 v[100:115], v[80:81], v[68:69], v[100:115]
    buffer_load_dwordx4 v19, s[8:11], s31 offen sc1 lds
    s_add_u32 s26, s31, 8192
    v_exp_f32 v130, v130
    v_exp_f32 v131, v131
    v_exp_f32 v148, v148
    v_exp_f32 v149, v149
    v_smfmac_f32_32x32x32_bf16 v[164:179], v[96:99], v[124:131], v18
    s_add_u32 m0, s31, 8192
    ds_read_b128 v[88:91], v16 offset:12448
    v_exp_f32 v150, v150
    v_exp_f32 v151, v151
    v_exp_f32 v152, v152
    v_exp_f32 v153, v153
    v_mfma_f32_32x32x16_bf16 v[132:147], v[72:75], v[64:67], 0
    buffer_load_dwordx4 v19, s[8:11], s26 offen sc1 lds
    v_exp_f32 v154, v154
    v_exp_f32 v155, v155
    v_exp_f32 v156, v156
    v_exp_f32 v157, v157
    v_smfmac_f32_32x32x32_bf16 v[180:195], v[92:95], v[148:155], v18
    s_add_u32 s31, s31, 16384
    s_waitcnt lgkmcnt(1)
    v_exp_f32 v158, v158
    v_exp_f32 v159, v159
    v_exp_f32 v160, v160
    v_exp_f32 v161, v161
    v_mfma_f32_32x32x8_bf16 v[132:147], v[80:81], v[70:71], v[132:147]
    v_exp_f32 v162, v162
    v_exp_f32 v163, v163
    s_waitcnt vmcnt(8)
    s_barrier
    v_exp_f32 v100, v100
    v_exp_f32 v101, v101
    v_smfmac_f32_32x32x32_bf16 v[180:195], v[96:99], v[156:163], v18
    s_mov_b32 m0, s31
    ds_read_b128 v[92:95], v16 offset:14400
    v_exp_f32 v102, v102
    v_exp_f32 v103, v103
    v_exp_f32 v104, v104
    v_exp_f32 v105, v105
    v_mfma_f32_32x32x16_bf16 v[116:131], v[76:79], v[60:63], 0
    ds_read_b128 v[72:75], v12 offset:15744
    v_exp_f32 v106, v106
    v_exp_f32 v107, v107
    v_exp_f32 v108, v108
    v_exp_f32 v109, v109
    v_smfmac_f32_32x32x32_bf16 v[164:179], v[84:87], v[100:107], v18
    s_waitcnt lgkmcnt(2)
    ds_read_b32 v80, v14 offset:16768
    v_exp_f32 v110, v110
    v_exp_f32 v111, v111
    v_exp_f32 v112, v112
    v_exp_f32 v113, v113
    v_mfma_f32_32x32x8_bf16 v[116:131], v[82:83], v[68:69], v[116:131]
    buffer_load_dwordx4 v19, s[8:11], s31 offen sc1 lds
    s_add_u32 s26, s31, 8192
    v_exp_f32 v114, v114
    v_exp_f32 v115, v115
    v_exp_f32 v132, v132
    v_exp_f32 v133, v133
    v_smfmac_f32_32x32x32_bf16 v[164:179], v[88:91], v[108:115], v18
    s_add_u32 m0, s31, 8192
    ds_read_b128 v[96:99], v16 offset:15072
    v_exp_f32 v134, v134
    v_exp_f32 v135, v135
    v_exp_f32 v136, v136
    v_exp_f32 v137, v137
    v_mfma_f32_32x32x16_bf16 v[148:163], v[76:79], v[64:67], 0
    buffer_load_dwordx4 v19, s[8:11], s26 offen sc1 lds
    v_exp_f32 v138, v138
    v_exp_f32 v139, v139
    v_exp_f32 v140, v140
    v_exp_f32 v141, v141
    v_smfmac_f32_32x32x32_bf16 v[180:195], v[84:87], v[132:139], v18
    s_add_u32 s31, s31, 16384
    s_waitcnt lgkmcnt(1)
    v_exp_f32 v142, v142
    v_exp_f32 v143, v143
    v_exp_f32 v144, v144
    v_exp_f32 v145, v145
    v_mfma_f32_32x32x8_bf16 v[148:163], v[82:83], v[70:71], v[148:163]
    v_exp_f32 v146, v146
    v_exp_f32 v147, v147
    v_exp_f32 v116, v116
    v_exp_f32 v117, v117
    v_smfmac_f32_32x32x32_bf16 v[180:195], v[88:91], v[140:147], v18
    s_mov_b32 m0, s31
    ds_read_b128 v[84:87], v16 offset:17024
    v_exp_f32 v118, v118
    v_exp_f32 v119, v119
    v_exp_f32 v120, v120
    v_exp_f32 v121, v121
    v_mfma_f32_32x32x16_bf16 v[100:115], v[72:75], v[60:63], 0
    ds_read_b128 v[76:79], v12 offset:18368
    v_exp_f32 v122, v122
    v_exp_f32 v123, v123
    v_exp_f32 v124, v124
    v_exp_f32 v125, v125
    v_smfmac_f32_32x32x32_bf16 v[164:179], v[92:95], v[116:123], v18
    s_waitcnt lgkmcnt(2)
    ds_read_b32 v82, v14 offset:19392
    v_exp_f32 v126, v126
    v_exp_f32 v127, v127
    v_exp_f32 v128, v128
    v_exp_f32 v129, v129
    v_mfma_f32_32x32x8_bf16 v[100:115], v[80:81], v[68:69], v[100:115]
    buffer_load_dwordx4 v19, s[8:11], s31 offen sc1 lds
    s_add_u32 s26, s31, 8192
    v_exp_f32 v130, v130
    v_exp_f32 v131, v131
    v_exp_f32 v148, v148
    v_exp_f32 v149, v149
    v_smfmac_f32_32x32x32_bf16 v[164:179], v[96:99], v[124:131], v18
    s_add_u32 m0, s31, 8192
    ds_read_b128 v[88:91], v16 offset:17696
    v_exp_f32 v150, v150
    v_exp_f32 v151, v151
    v_exp_f32 v152, v152
    v_exp_f32 v153, v153
    v_mfma_f32_32x32x16_bf16 v[132:147], v[72:75], v[64:67], 0
    buffer_load_dwordx4 v19, s[8:11], s26 offen sc1 lds
    v_exp_f32 v154, v154
    v_exp_f32 v155, v155
    v_exp_f32 v156, v156
    v_exp_f32 v157, v157
    v_smfmac_f32_32x32x32_bf16 v[180:195], v[92:95], v[148:155], v18
    s_add_u32 s31, s31, 16384
    s_waitcnt lgkmcnt(1)
    v_exp_f32 v158, v158
    v_exp_f32 v159, v159
    v_exp_f32 v160, v160
    v_exp_f32 v161, v161
    v_mfma_f32_32x32x8_bf16 v[132:147], v[80:81], v[70:71], v[132:147]
    v_exp_f32 v162, v162
    v_exp_f32 v163, v163
    v_exp_f32 v100, v100
    v_exp_f32 v101, v101
    v_smfmac_f32_32x32x32_bf16 v[180:195], v[96:99], v[156:163], v18
    s_mov_b32 m0, s31
    ds_read_b128 v[92:95], v16 offset:19648
    v_exp_f32 v102, v102
    v_exp_f32 v103, v103
    v_exp_f32 v104, v104
    v_exp_f32 v105, v105
    v_mfma_f32_32x32x16_bf16 v[116:131], v[76:79], v[60:63], 0
    ds_read_b128 v[72:75], v12 offset:20992
    v_exp_f32 v106, v106
    v_exp_f32 v107, v107
    v_exp_f32 v108, v108
    v_exp_f32 v109, v109
    v_smfmac_f32_32x32x32_bf16 v[164:179], v[84:87], v[100:107], v18
    s_waitcnt lgkmcnt(2)
    ds_read_b32 v80, v14 offset:22016
    v_exp_f32 v110, v110
    v_exp_f32 v111, v111
    v_exp_f32 v112, v112
    v_exp_f32 v113, v113
    v_mfma_f32_32x32x8_bf16 v[116:131], v[82:83], v[68:69], v[116:131]
    buffer_load_dwordx4 v19, s[8:11], s31 offen sc1 lds
    s_add_u32 s26, s31, 8192
    v_exp_f32 v114, v114
    v_exp_f32 v115, v115
    v_exp_f32 v132, v132
    v_exp_f32 v133, v133
    v_smfmac_f32_32x32x32_bf16 v[164:179], v[88:91], v[108:115], v18
    s_add_u32 m0, s31, 8192
    ds_read_b128 v[96:99], v16 offset:20320
    v_exp_f32 v134, v134
    v_exp_f32 v135, v135
    v_exp_f32 v136, v136
    v_exp_f32 v137, v137
    v_mfma_f32_32x32x16_bf16 v[148:163], v[76:79], v[64:67], 0
    buffer_load_dwordx4 v19, s[8:11], s26 offen sc1 lds
    v_exp_f32 v138, v138
    v_exp_f32 v139, v139
    v_exp_f32 v140, v140
    v_exp_f32 v141, v141
    v_smfmac_f32_32x32x32_bf16 v[180:195], v[84:87], v[132:139], v18
    s_add_u32 s31, s31, 16384
    s_waitcnt lgkmcnt(1)
    v_exp_f32 v142, v142
    v_exp_f32 v143, v143
    v_exp_f32 v144, v144
    v_exp_f32 v145, v145
    v_mfma_f32_32x32x8_bf16 v[148:163], v[82:83], v[70:71], v[148:163]
    v_exp_f32 v146, v146
    v_exp_f32 v147, v147
    v_exp_f32 v116, v116
    v_exp_f32 v117, v117
    v_smfmac_f32_32x32x32_bf16 v[180:195], v[88:91], v[140:147], v18
    s_mov_b32 m0, s31
    ds_read_b128 v[84:87], v16 offset:22272
    v_exp_f32 v118, v118
    v_exp_f32 v119, v119
    v_exp_f32 v120, v120
    v_exp_f32 v121, v121
    v_mfma_f32_32x32x16_bf16 v[100:115], v[72:75], v[60:63], 0
    ds_read_b128 v[76:79], v12 offset:23616
    v_exp_f32 v122, v122
    v_exp_f32 v123, v123
    v_exp_f32 v124, v124
    v_exp_f32 v125, v125
    v_smfmac_f32_32x32x32_bf16 v[164:179], v[92:95], v[116:123], v18
    s_waitcnt lgkmcnt(2)
    ds_read_b32 v82, v14 offset:24640
    v_exp_f32 v126, v126
    v_exp_f32 v127, v127
    v_exp_f32 v128, v128
    v_exp_f32 v129, v129
    v_mfma_f32_32x32x8_bf16 v[100:115], v[80:81], v[68:69], v[100:115]
    buffer_load_dwordx4 v19, s[8:11], s31 offen sc1 lds
    s_add_u32 s26, s31, 8192
    v_exp_f32 v130, v130
    v_exp_f32 v131, v131
    v_exp_f32 v148, v148
    v_exp_f32 v149, v149
    v_smfmac_f32_32x32x32_bf16 v[164:179], v[96:99], v[124:131], v18
    s_add_u32 m0, s31, 8192
    ds_read_b128 v[88:91], v16 offset:22944
    v_exp_f32 v150, v150
    v_exp_f32 v151, v151
    v_exp_f32 v152, v152
    v_exp_f32 v153, v153
    v_mfma_f32_32x32x16_bf16 v[132:147], v[72:75], v[64:67], 0
    buffer_load_dwordx4 v19, s[8:11], s26 offen sc1 lds
    v_exp_f32 v154, v154
    v_exp_f32 v155, v155
    v_exp_f32 v156, v156
    v_exp_f32 v157, v157
    v_smfmac_f32_32x32x32_bf16 v[180:195], v[92:95], v[148:155], v18
    s_add_u32 s31, s31, 16384
    s_waitcnt lgkmcnt(1)
    v_exp_f32 v158, v158
    v_exp_f32 v159, v159
    v_exp_f32 v160, v160
    v_exp_f32 v161, v161
    v_mfma_f32_32x32x8_bf16 v[132:147], v[80:81], v[70:71], v[132:147]
    v_exp_f32 v162, v162
    v_exp_f32 v163, v163
    s_waitcnt vmcnt(8)
    s_barrier
    v_exp_f32 v100, v100
    v_exp_f32 v101, v101
    v_smfmac_f32_32x32x32_bf16 v[180:195], v[96:99], v[156:163], v18
    ds_read_b128 v[92:95], v16 offset:24896
    v_exp_f32 v102, v102
    v_exp_f32 v103, v103
    v_exp_f32 v104, v104
    v_exp_f32 v105, v105
    v_mfma_f32_32x32x16_bf16 v[116:131], v[76:79], v[60:63], 0
    ds_read_b128 v[72:75], v12 offset:26240
    v_exp_f32 v106, v106
    v_exp_f32 v107, v107
    v_exp_f32 v108, v108
    v_exp_f32 v109, v109
    v_smfmac_f32_32x32x32_bf16 v[164:179], v[84:87], v[100:107], v18
    s_waitcnt lgkmcnt(2)
    ds_read_b32 v80, v14 offset:27264
    v_exp_f32 v110, v110
    v_exp_f32 v111, v111
    v_exp_f32 v112, v112
    v_exp_f32 v113, v113
    v_mfma_f32_32x32x8_bf16 v[116:131], v[82:83], v[68:69], v[116:131]
    v_exp_f32 v114, v114
    v_exp_f32 v115, v115
    v_exp_f32 v132, v132
    v_exp_f32 v133, v133
    v_smfmac_f32_32x32x32_bf16 v[164:179], v[88:91], v[108:115], v18
    ds_read_b128 v[96:99], v16 offset:25568
    v_exp_f32 v134, v134
    v_exp_f32 v135, v135
    v_exp_f32 v136, v136
    v_exp_f32 v137, v137
    v_mfma_f32_32x32x16_bf16 v[148:163], v[76:79], v[64:67], 0
    v_exp_f32 v138, v138
    v_exp_f32 v139, v139
    v_exp_f32 v140, v140
    v_exp_f32 v141, v141
    v_smfmac_f32_32x32x32_bf16 v[180:195], v[84:87], v[132:139], v18
    s_waitcnt lgkmcnt(1)
    v_exp_f32 v142, v142
    v_exp_f32 v143, v143
    v_exp_f32 v144, v144
    v_exp_f32 v145, v145
    v_mfma_f32_32x32x8_bf16 v[148:163], v[82:83], v[70:71], v[148:163]
    v_exp_f32 v146, v146
    v_exp_f32 v147, v147
    v_exp_f32 v116, v116
    v_exp_f32 v117, v117
    v_smfmac_f32_32x32x32_bf16 v[180:195], v[88:91], v[140:147], v18
    ds_read_b128 v[84:87], v16 offset:27520
    v_exp_f32 v118, v118
    v_exp_f32 v119, v119
    v_exp_f32 v120, v120
    v_exp_f32 v121, v121
    v_mfma_f32_32x32x16_bf16 v[100:115], v[72:75], v[60:63], 0
    ds_read_b128 v[76:79], v12 offset:28864
    v_exp_f32 v122, v122
    v_exp_f32 v123, v123
    v_exp_f32 v124, v124
    v_exp_f32 v125, v125
    v_smfmac_f32_32x32x32_bf16 v[164:179], v[92:95], v[116:123], v18
    s_waitcnt lgkmcnt(2)
    ds_read_b32 v82, v14 offset:29888
    v_exp_f32 v126, v126
    v_exp_f32 v127, v127
    v_exp_f32 v128, v128
    v_exp_f32 v129, v129
    v_mfma_f32_32x32x8_bf16 v[100:115], v[80:81], v[68:69], v[100:115]
    v_exp_f32 v130, v130
    v_exp_f32 v131, v131
    v_exp_f32 v148, v148
    v_exp_f32 v149, v149
    v_smfmac_f32_32x32x32_bf16 v[164:179], v[96:99], v[124:131], v18
    ds_read_b128 v[88:91], v16 offset:28192
    v_exp_f32 v150, v150
    v_exp_f32 v151, v151
    v_exp_f32 v152, v152
    v_exp_f32 v153, v153
    v_mfma_f32_32x32x16_bf16 v[132:147], v[72:75], v[64:67], 0
    v_exp_f32 v154, v154
    v_exp_f32 v155, v155
    v_exp_f32 v156, v156
    v_exp_f32 v157, v157
    v_smfmac_f32_32x32x32_bf16 v[180:195], v[92:95], v[148:155], v18
    s_waitcnt lgkmcnt(1)
    v_exp_f32 v158, v158
    v_exp_f32 v159, v159
    v_exp_f32 v160, v160
    v_exp_f32 v161, v161
    v_mfma_f32_32x32x8_bf16 v[132:147], v[80:81], v[70:71], v[132:147]
    v_exp_f32 v162, v162
    v_exp_f32 v163, v163
    v_exp_f32 v100, v100
    v_exp_f32 v101, v101
    v_smfmac_f32_32x32x32_bf16 v[180:195], v[96:99], v[156:163], v18
    ds_read_b128 v[92:95], v16 offset:30144
    v_exp_f32 v102, v102
    v_exp_f32 v103, v103
    v_exp_f32 v104, v104
    v_exp_f32 v105, v105
    v_mfma_f32_32x32x16_bf16 v[116:131], v[76:79], v[60:63], 0
    ds_read_b128 v[72:75], v13 offset:0
    v_exp_f32 v106, v106
    v_exp_f32 v107, v107
    v_exp_f32 v108, v108
    v_exp_f32 v109, v109
    v_smfmac_f32_32x32x32_bf16 v[164:179], v[84:87], v[100:107], v18
    s_waitcnt lgkmcnt(2)
    ds_read_b32 v80, v15 offset:1024
    v_exp_f32 v110, v110
    v_exp_f32 v111, v111
    v_exp_f32 v112, v112
    v_exp_f32 v113, v113
    v_mfma_f32_32x32x8_bf16 v[116:131], v[82:83], v[68:69], v[116:131]
    v_exp_f32 v114, v114
    v_exp_f32 v115, v115
    v_exp_f32 v132, v132
    v_exp_f32 v133, v133
    v_smfmac_f32_32x32x32_bf16 v[164:179], v[88:91], v[108:115], v18
    ds_read_b128 v[96:99], v16 offset:30816
    v_exp_f32 v134, v134
    v_exp_f32 v135, v135
    v_exp_f32 v136, v136
    v_exp_f32 v137, v137
    v_mfma_f32_32x32x16_bf16 v[148:163], v[76:79], v[64:67], 0
    v_exp_f32 v138, v138
    v_exp_f32 v139, v139
    v_exp_f32 v140, v140
    v_exp_f32 v141, v141
    v_smfmac_f32_32x32x32_bf16 v[180:195], v[84:87], v[132:139], v18
    s_waitcnt lgkmcnt(1)
    v_exp_f32 v142, v142
    v_exp_f32 v143, v143
    v_exp_f32 v144, v144
    v_exp_f32 v145, v145
    v_mfma_f32_32x32x8_bf16 v[148:163], v[82:83], v[70:71], v[148:163]
    v_exp_f32 v146, v146
    v_exp_f32 v147, v147
    v_exp_f32 v116, v116
    v_exp_f32 v117, v117
    v_smfmac_f32_32x32x32_bf16 v[180:195], v[88:91], v[140:147], v18
    ds_read_b128 v[84:87], v17 offset:1280
    v_exp_f32 v118, v118
    v_exp_f32 v119, v119
    v_exp_f32 v120, v120
    v_exp_f32 v121, v121
    v_mfma_f32_32x32x16_bf16 v[100:115], v[72:75], v[60:63], 0
    ds_read_b128 v[76:79], v13 offset:2624
    v_exp_f32 v122, v122
    v_exp_f32 v123, v123
    v_exp_f32 v124, v124
    v_exp_f32 v125, v125
    v_smfmac_f32_32x32x32_bf16 v[164:179], v[92:95], v[116:123], v18
    s_waitcnt lgkmcnt(2)
    ds_read_b32 v82, v15 offset:3648
    v_exp_f32 v126, v126
    v_exp_f32 v127, v127
    v_exp_f32 v128, v128
    v_exp_f32 v129, v129
    v_mfma_f32_32x32x8_bf16 v[100:115], v[80:81], v[68:69], v[100:115]
    v_exp_f32 v130, v130
    v_exp_f32 v131, v131
    v_exp_f32 v148, v148
    v_exp_f32 v149, v149
    v_smfmac_f32_32x32x32_bf16 v[164:179], v[96:99], v[124:131], v18
    ds_read_b128 v[88:91], v17 offset:1952
    v_exp_f32 v150, v150
    v_exp_f32 v151, v151
    v_exp_f32 v152, v152
    v_exp_f32 v153, v153
    v_mfma_f32_32x32x16_bf16 v[132:147], v[72:75], v[64:67], 0
    v_exp_f32 v154, v154
    v_exp_f32 v155, v155
    v_exp_f32 v156, v156
    v_exp_f32 v157, v157
    v_smfmac_f32_32x32x32_bf16 v[180:195], v[92:95], v[148:155], v18
    s_waitcnt lgkmcnt(1)
    v_exp_f32 v158, v158
    v_exp_f32 v159, v159
    v_exp_f32 v160, v160
    v_exp_f32 v161, v161
    v_mfma_f32_32x32x8_bf16 v[132:147], v[80:81], v[70:71], v[132:147]
    v_exp_f32 v162, v162
    v_exp_f32 v163, v163
    v_exp_f32 v100, v100
    v_exp_f32 v101, v101
    v_smfmac_f32_32x32x32_bf16 v[180:195], v[96:99], v[156:163], v18
    ds_read_b128 v[92:95], v17 offset:3904
    v_exp_f32 v102, v102
    v_exp_f32 v103, v103
    v_exp_f32 v104, v104
    v_exp_f32 v105, v105
    v_mfma_f32_32x32x16_bf16 v[116:131], v[76:79], v[60:63], 0
    ds_read_b128 v[72:75], v13 offset:5248
    v_exp_f32 v106, v106
    v_exp_f32 v107, v107
    v_exp_f32 v108, v108
    v_exp_f32 v109, v109
    v_smfmac_f32_32x32x32_bf16 v[164:179], v[84:87], v[100:107], v18
    s_waitcnt lgkmcnt(2)
    ds_read_b32 v80, v15 offset:6272
    v_exp_f32 v110, v110
    v_exp_f32 v111, v111
    v_exp_f32 v112, v112
    v_exp_f32 v113, v113
    v_mfma_f32_32x32x8_bf16 v[116:131], v[82:83], v[68:69], v[116:131]
    v_exp_f32 v114, v114
    v_exp_f32 v115, v115
    v_exp_f32 v132, v132
    v_exp_f32 v133, v133
    v_smfmac_f32_32x32x32_bf16 v[164:179], v[88:91], v[108:115], v18
    ds_read_b128 v[96:99], v17 offset:4576
    v_exp_f32 v134, v134
    v_exp_f32 v135, v135
    v_exp_f32 v136, v136
    v_exp_f32 v137, v137
    v_mfma_f32_32x32x16_bf16 v[148:163], v[76:79], v[64:67], 0
    v_exp_f32 v138, v138
    v_exp_f32 v139, v139
    v_exp_f32 v140, v140
    v_exp_f32 v141, v141
    v_smfmac_f32_32x32x32_bf16 v[180:195], v[84:87], v[132:139], v18
    s_waitcnt lgkmcnt(1)
    v_exp_f32 v142, v142
    v_exp_f32 v143, v143
    v_exp_f32 v144, v144
    v_exp_f32 v145, v145
    v_mfma_f32_32x32x8_bf16 v[148:163], v[82:83], v[70:71], v[148:163]
    v_exp_f32 v146, v146
    v_exp_f32 v147, v147
    v_exp_f32 v116, v116
    v_exp_f32 v117, v117
    v_smfmac_f32_32x32x32_bf16 v[180:195], v[88:91], v[140:147], v18
    ds_read_b128 v[84:87], v17 offset:6528
    v_exp_f32 v118, v118
    v_exp_f32 v119, v119
    v_exp_f32 v120, v120
    v_exp_f32 v121, v121
    v_mfma_f32_32x32x16_bf16 v[100:115], v[72:75], v[60:63], 0
    ds_read_b128 v[76:79], v13 offset:7872
    v_exp_f32 v122, v122
    v_exp_f32 v123, v123
    v_exp_f32 v124, v124
    v_exp_f32 v125, v125
    v_smfmac_f32_32x32x32_bf16 v[164:179], v[92:95], v[116:123], v18
    s_waitcnt lgkmcnt(2)
    ds_read_b32 v82, v15 offset:8896
    v_exp_f32 v126, v126
    v_exp_f32 v127, v127
    v_exp_f32 v128, v128
    v_exp_f32 v129, v129
    v_mfma_f32_32x32x8_bf16 v[100:115], v[80:81], v[68:69], v[100:115]
    v_exp_f32 v130, v130
    v_exp_f32 v131, v131
    v_exp_f32 v148, v148
    v_exp_f32 v149, v149
    v_smfmac_f32_32x32x32_bf16 v[164:179], v[96:99], v[124:131], v18
    ds_read_b128 v[88:91], v17 offset:7200
    v_exp_f32 v150, v150
    v_exp_f32 v151, v151
    v_exp_f32 v152, v152
    v_exp_f32 v153, v153
    v_mfma_f32_32x32x16_bf16 v[132:147], v[72:75], v[64:67], 0
    v_exp_f32 v154, v154
    v_exp_f32 v155, v155
    v_exp_f32 v156, v156
    v_exp_f32 v157, v157
    v_smfmac_f32_32x32x32_bf16 v[180:195], v[92:95], v[148:155], v18
    s_waitcnt lgkmcnt(1)
    v_exp_f32 v158, v158
    v_exp_f32 v159, v159
    v_exp_f32 v160, v160
    v_exp_f32 v161, v161
    v_mfma_f32_32x32x8_bf16 v[132:147], v[80:81], v[70:71], v[132:147]
    v_exp_f32 v162, v162
    v_exp_f32 v163, v163
    v_exp_f32 v100, v100
    v_exp_f32 v101, v101
    v_smfmac_f32_32x32x32_bf16 v[180:195], v[96:99], v[156:163], v18
    ds_read_b128 v[92:95], v17 offset:9152
    v_exp_f32 v102, v102
    v_exp_f32 v103, v103
    v_exp_f32 v104, v104
    v_exp_f32 v105, v105
    v_mfma_f32_32x32x16_bf16 v[116:131], v[76:79], v[60:63], 0
    ds_read_b128 v[72:75], v12 offset:41984
    v_exp_f32 v106, v106
    v_exp_f32 v107, v107
    v_exp_f32 v108, v108
    v_exp_f32 v109, v109
    v_smfmac_f32_32x32x32_bf16 v[164:179], v[84:87], v[100:107], v18
    s_waitcnt lgkmcnt(2)
    ds_read_b32 v80, v14 offset:43008
    v_exp_f32 v110, v110
    v_exp_f32 v111, v111
    v_exp_f32 v112, v112
    v_exp_f32 v113, v113
    v_mfma_f32_32x32x8_bf16 v[116:131], v[82:83], v[68:69], v[116:131]
    v_exp_f32 v114, v114
    v_exp_f32 v115, v115
    v_exp_f32 v132, v132
    v_exp_f32 v133, v133
    v_smfmac_f32_32x32x32_bf16 v[164:179], v[88:91], v[108:115], v18
    ds_read_b128 v[96:99], v17 offset:9824
    v_exp_f32 v134, v134
    v_exp_f32 v135, v135
    v_exp_f32 v136, v136
    v_exp_f32 v137, v137
    v_mfma_f32_32x32x16_bf16 v[148:163], v[76:79], v[64:67], 0
    v_exp_f32 v138, v138
    v_exp_f32 v139, v139
    v_exp_f32 v140, v140
    v_exp_f32 v141, v141
    v_smfmac_f32_32x32x32_bf16 v[180:195], v[84:87], v[132:139], v18
    s_waitcnt lgkmcnt(1)
    v_exp_f32 v142, v142
    v_exp_f32 v143, v143
    v_exp_f32 v144, v144
    v_exp_f32 v145, v145
    v_mfma_f32_32x32x8_bf16 v[148:163], v[82:83], v[70:71], v[148:163]
    v_exp_f32 v146, v146
    v_exp_f32 v147, v147
    v_exp_f32 v116, v116
    v_exp_f32 v117, v117
    v_smfmac_f32_32x32x32_bf16 v[180:195], v[88:91], v[140:147], v18
    ds_read_b128 v[84:87], v16 offset:43264
    v_exp_f32 v118, v118
    v_exp_f32 v119, v119
    v_exp_f32 v120, v120
    v_exp_f32 v121, v121
    v_mfma_f32_32x32x16_bf16 v[100:115], v[72:75], v[60:63], 0
    ds_read_b128 v[76:79], v12 offset:44608
    v_exp_f32 v122, v122
    v_exp_f32 v123, v123
    v_exp_f32 v124, v124
    v_exp_f32 v125, v125
    v_smfmac_f32_32x32x32_bf16 v[164:179], v[92:95], v[116:123], v18
    s_waitcnt lgkmcnt(2)
    ds_read_b32 v82, v14 offset:45632
    v_exp_f32 v126, v126
    v_exp_f32 v127, v127
    v_exp_f32 v128, v128
    v_exp_f32 v129, v129
    v_mfma_f32_32x32x8_bf16 v[100:115], v[80:81], v[68:69], v[100:115]
    v_exp_f32 v130, v130
    v_exp_f32 v131, v131
    v_exp_f32 v148, v148
    v_exp_f32 v149, v149
    v_smfmac_f32_32x32x32_bf16 v[164:179], v[96:99], v[124:131], v18
    ds_read_b128 v[88:91], v16 offset:43936
    v_exp_f32 v150, v150
    v_exp_f32 v151, v151
    v_exp_f32 v152, v152
    v_exp_f32 v153, v153
    v_mfma_f32_32x32x16_bf16 v[132:147], v[72:75], v[64:67], 0
    v_exp_f32 v154, v154
    v_exp_f32 v155, v155
    v_exp_f32 v156, v156
    v_exp_f32 v157, v157
    v_smfmac_f32_32x32x32_bf16 v[180:195], v[92:95], v[148:155], v18
    s_waitcnt lgkmcnt(1)
    v_exp_f32 v158, v158
    v_exp_f32 v159, v159
    v_exp_f32 v160, v160
    v_exp_f32 v161, v161
    v_mfma_f32_32x32x8_bf16 v[132:147], v[80:81], v[70:71], v[132:147]
    v_exp_f32 v162, v162
    v_exp_f32 v163, v163
    s_lshl_b32 s23, s20, 11
    s_min_u32 s24, s23, 9472
    s_mov_b32 m0, s24
    s_add_u32 s31, s24, 157440
    buffer_load_dwordx4 v19, s[8:11], s31 offen sc1 lds
    s_add_u32 s23, s23, 1024
    s_min_u32 s24, s23, 9472
    s_mov_b32 m0, s24
    s_add_u32 s31, s24, 157440
    buffer_load_dwordx4 v19, s[8:11], s31 offen sc1 lds
    s_mov_b32 s27, 1
    v_add_u32 v12, 41984, v12
    v_add_u32 v14, 41984, v14
    v_add_u32 v16, 41984, v16
    s_cmp_eq_u32 s27, 3
    s_mov_b32 s23, 41984
    s_cmov_b32 s23, 4294851840
    v_add_u32 v13, s23, v13
    v_add_u32 v15, s23, v15
    v_add_u32 v17, s23, v17
.p2align 6
L_loop:
    v_exp_f32 v100, v100
    v_exp_f32 v101, v101
    v_smfmac_f32_32x32x32_bf16 v[180:195], v[96:99], v[156:163], v18
    ds_read_b128 v[92:95], v16 offset:3904
    v_exp_f32 v102, v102
    v_exp_f32 v103, v103
    v_exp_f32 v104, v104
    v_exp_f32 v105, v105
    v_mfma_f32_32x32x16_bf16 v[116:131], v[76:79], v[60:63], 0
    ds_read_b128 v[72:75], v12 offset:5248
    v_exp_f32 v106, v106
    v_exp_f32 v107, v107
    v_exp_f32 v108, v108
    v_exp_f32 v109, v109
    v_smfmac_f32_32x32x32_bf16 v[164:179], v[84:87], v[100:107], v18
    s_waitcnt lgkmcnt(2)
    ds_read_b32 v80, v14 offset:6272
    v_exp_f32 v110, v110
    v_exp_f32 v111, v111
    v_exp_f32 v112, v112
    v_exp_f32 v113, v113
    v_mfma_f32_32x32x8_bf16 v[116:131], v[82:83], v[68:69], v[116:131]
    v_exp_f32 v114, v114
    v_exp_f32 v115, v115
    v_exp_f32 v132, v132
    v_exp_f32 v133, v133
    v_smfmac_f32_32x32x32_bf16 v[164:179], v[88:91], v[108:115], v18
    ds_read_b128 v[96:99], v16 offset:4576
    v_exp_f32 v134, v134
    v_exp_f32 v135, v135
    v_exp_f32 v136, v136
    v_exp_f32 v137, v137
    v_mfma_f32_32x32x16_bf16 v[148:163], v[76:79], v[64:67], 0
    v_exp_f32 v138, v138
    v_exp_f32 v139, v139
    v_exp_f32 v140, v140
    v_exp_f32 v141, v141
    v_smfmac_f32_32x32x32_bf16 v[180:195], v[84:87], v[132:139], v18
    s_waitcnt lgkmcnt(1)
    v_exp_f32 v142, v142
    v_exp_f32 v143, v143
    v_exp_f32 v144, v144
    v_exp_f32 v145, v145
    v_mfma_f32_32x32x8_bf16 v[148:163], v[82:83], v[70:71], v[148:163]
    v_exp_f32 v146, v146
    v_exp_f32 v147, v147
    v_exp_f32 v116, v116
    v_exp_f32 v117, v117
    v_smfmac_f32_32x32x32_bf16 v[180:195], v[88:91], v[140:147], v18
    ds_read_b128 v[84:87], v16 offset:6528
    v_exp_f32 v118, v118
    v_exp_f32 v119, v119
    v_exp_f32 v120, v120
    v_exp_f32 v121, v121
    v_mfma_f32_32x32x16_bf16 v[100:115], v[72:75], v[60:63], 0
    ds_read_b128 v[76:79], v12 offset:7872
    v_exp_f32 v122, v122
    v_exp_f32 v123, v123
    v_exp_f32 v124, v124
    v_exp_f32 v125, v125
    v_smfmac_f32_32x32x32_bf16 v[164:179], v[92:95], v[116:123], v18
    s_waitcnt lgkmcnt(2)
    ds_read_b32 v82, v14 offset:8896
    v_exp_f32 v126, v126
    v_exp_f32 v127, v127
    v_exp_f32 v128, v128
    v_exp_f32 v129, v129
    v_mfma_f32_32x32x8_bf16 v[100:115], v[80:81], v[68:69], v[100:115]
    v_exp_f32 v130, v130
    v_exp_f32 v131, v131
    v_exp_f32 v148, v148
    v_exp_f32 v149, v149
    v_smfmac_f32_32x32x32_bf16 v[164:179], v[96:99], v[124:131], v18
    ds_read_b128 v[88:91], v16 offset:7200
    v_exp_f32 v150, v150
    v_exp_f32 v151, v151
    v_exp_f32 v152, v152
    v_exp_f32 v153, v153
    v_mfma_f32_32x32x16_bf16 v[132:147], v[72:75], v[64:67], 0
    v_exp_f32 v154, v154
    v_exp_f32 v155, v155
    v_exp_f32 v156, v156
    v_exp_f32 v157, v157
    v_smfmac_f32_32x32x32_bf16 v[180:195], v[92:95], v[148:155], v18
    s_waitcnt lgkmcnt(1)
    v_exp_f32 v158, v158
    v_exp_f32 v159, v159
    v_exp_f32 v160, v160
    v_exp_f32 v161, v161
    v_mfma_f32_32x32x8_bf16 v[132:147], v[80:81], v[70:71], v[132:147]
    v_exp_f32 v162, v162
    v_exp_f32 v163, v163
    v_exp_f32 v100, v100
    v_exp_f32 v101, v101
    v_smfmac_f32_32x32x32_bf16 v[180:195], v[96:99], v[156:163], v18
    ds_read_b128 v[92:95], v16 offset:9152
    v_exp_f32 v102, v102
    v_exp_f32 v103, v103
    v_exp_f32 v104, v104
    v_exp_f32 v105, v105
    v_mfma_f32_32x32x16_bf16 v[116:131], v[76:79], v[60:63], 0
    ds_read_b128 v[72:75], v12 offset:10496
    v_exp_f32 v106, v106
    v_exp_f32 v107, v107
    v_exp_f32 v108, v108
    v_exp_f32 v109, v109
    v_smfmac_f32_32x32x32_bf16 v[164:179], v[84:87], v[100:107], v18
    s_waitcnt lgkmcnt(2)
    ds_read_b32 v80, v14 offset:11520
    v_exp_f32 v110, v110
    v_exp_f32 v111, v111
    v_exp_f32 v112, v112
    v_exp_f32 v113, v113
    v_mfma_f32_32x32x8_bf16 v[116:131], v[82:83], v[68:69], v[116:131]
    v_exp_f32 v114, v114
    v_exp_f32 v115, v115
    v_exp_f32 v132, v132
    v_exp_f32 v133, v133
    v_smfmac_f32_32x32x32_bf16 v[164:179], v[88:91], v[108:115], v18
    ds_read_b128 v[96:99], v16 offset:9824
    v_exp_f32 v134, v134
    v_exp_f32 v135, v135
    v_exp_f32 v136, v136
    v_exp_f32 v137, v137
    v_mfma_f32_32x32x16_bf16 v[148:163], v[76:79], v[64:67], 0
    v_exp_f32 v138, v138
    v_exp_f32 v139, v139
    v_exp_f32 v140, v140
    v_exp_f32 v141, v141
    v_smfmac_f32_32x32x32_bf16 v[180:195], v[84:87], v[132:139], v18
    s_waitcnt lgkmcnt(1)
    v_exp_f32 v142, v142
    v_exp_f32 v143, v143
    v_exp_f32 v144, v144
    v_exp_f32 v145, v145
    v_mfma_f32_32x32x8_bf16 v[148:163], v[82:83], v[70:71], v[148:163]
    v_exp_f32 v146, v146
    v_exp_f32 v147, v147
    v_exp_f32 v116, v116
    v_exp_f32 v117, v117
    v_smfmac_f32_32x32x32_bf16 v[180:195], v[88:91], v[140:147], v18
    ds_read_b128 v[84:87], v16 offset:11776
    v_exp_f32 v118, v118
    v_exp_f32 v119, v119
    v_exp_f32 v120, v120
    v_exp_f32 v121, v121
    v_mfma_f32_32x32x16_bf16 v[100:115], v[72:75], v[60:63], 0
    ds_read_b128 v[76:79], v12 offset:13120
    v_exp_f32 v122, v122
    v_exp_f32 v123, v123
    v_exp_f32 v124, v124
    v_exp_f32 v125, v125
    v_smfmac_f32_32x32x32_bf16 v[164:179], v[92:95], v[116:123], v18
    s_waitcnt lgkmcnt(2)
    ds_read_b32 v82, v14 offset:14144
    v_exp_f32 v126, v126
    v_exp_f32 v127, v127
    v_exp_f32 v128, v128
    v_exp_f32 v129, v129
    v_mfma_f32_32x32x8_bf16 v[100:115], v[80:81], v[68:69], v[100:115]
    v_exp_f32 v130, v130
    v_exp_f32 v131, v131
    v_exp_f32 v148, v148
    v_exp_f32 v149, v149
    v_smfmac_f32_32x32x32_bf16 v[164:179], v[96:99], v[124:131], v18
    ds_read_b128 v[88:91], v16 offset:12448
    v_exp_f32 v150, v150
    v_exp_f32 v151, v151
    v_exp_f32 v152, v152
    v_exp_f32 v153, v153
    v_mfma_f32_32x32x16_bf16 v[132:147], v[72:75], v[64:67], 0
    v_exp_f32 v154, v154
    v_exp_f32 v155, v155
    v_exp_f32 v156, v156
    v_exp_f32 v157, v157
    v_smfmac_f32_32x32x32_bf16 v[180:195], v[92:95], v[148:155], v18
    s_waitcnt lgkmcnt(1)
    v_exp_f32 v158, v158
    v_exp_f32 v159, v159
    v_exp_f32 v160, v160
    v_exp_f32 v161, v161
    v_mfma_f32_32x32x8_bf16 v[132:147], v[80:81], v[70:71], v[132:147]
    v_exp_f32 v162, v162
    v_exp_f32 v163, v163
    v_exp_f32 v100, v100
    v_exp_f32 v101, v101
    v_smfmac_f32_32x32x32_bf16 v[180:195], v[96:99], v[156:163], v18
    ds_read_b128 v[92:95], v16 offset:14400
    v_exp_f32 v102, v102
    v_exp_f32 v103, v103
    v_exp_f32 v104, v104
    v_exp_f32 v105, v105
    v_mfma_f32_32x32x16_bf16 v[116:131], v[76:79], v[60:63], 0
    ds_read_b128 v[72:75], v12 offset:15744
    v_exp_f32 v106, v106
    v_exp_f32 v107, v107
    v_exp_f32 v108, v108
    v_exp_f32 v109, v109
    v_smfmac_f32_32x32x32_bf16 v[164:179], v[84:87], v[100:107], v18
    s_waitcnt lgkmcnt(2)
    ds_read_b32 v80, v14 offset:16768
    v_exp_f32 v110, v110
    v_exp_f32 v111, v111
    v_exp_f32 v112, v112
    v_exp_f32 v113, v113
    v_mfma_f32_32x32x8_bf16 v[116:131], v[82:83], v[68:69], v[116:131]
    v_exp_f32 v114, v114
    v_exp_f32 v115, v115
    v_exp_f32 v132, v132
    v_exp_f32 v133, v133
    v_smfmac_f32_32x32x32_bf16 v[164:179], v[88:91], v[108:115], v18
    ds_read_b128 v[96:99], v16 offset:15072
    v_exp_f32 v134, v134
    v_exp_f32 v135, v135
    v_exp_f32 v136, v136
    v_exp_f32 v137, v137
    v_mfma_f32_32x32x16_bf16 v[148:163], v[76:79], v[64:67], 0
    v_exp_f32 v138, v138
    v_exp_f32 v139, v139
    v_exp_f32 v140, v140
    v_exp_f32 v141, v141
    v_smfmac_f32_32x32x32_bf16 v[180:195], v[84:87], v[132:139], v18
    s_waitcnt lgkmcnt(1)
    v_exp_f32 v142, v142
    v_exp_f32 v143, v143
    v_exp_f32 v144, v144
    v_exp_f32 v145, v145
    v_mfma_f32_32x32x8_bf16 v[148:163], v[82:83], v[70:71], v[148:163]
    v_exp_f32 v146, v146
    v_exp_f32 v147, v147
    v_exp_f32 v116, v116
    v_exp_f32 v117, v117
    v_smfmac_f32_32x32x32_bf16 v[180:195], v[88:91], v[140:147], v18
    ds_read_b128 v[84:87], v16 offset:17024
    v_exp_f32 v118, v118
    v_exp_f32 v119, v119
    v_exp_f32 v120, v120
    v_exp_f32 v121, v121
    v_mfma_f32_32x32x16_bf16 v[100:115], v[72:75], v[60:63], 0
    ds_read_b128 v[76:79], v12 offset:18368
    v_exp_f32 v122, v122
    v_exp_f32 v123, v123
    v_exp_f32 v124, v124
    v_exp_f32 v125, v125
    v_smfmac_f32_32x32x32_bf16 v[164:179], v[92:95], v[116:123], v18
    s_waitcnt lgkmcnt(2)
    ds_read_b32 v82, v14 offset:19392
    v_exp_f32 v126, v126
    v_exp_f32 v127, v127
    v_exp_f32 v128, v128
    v_exp_f32 v129, v129
    v_mfma_f32_32x32x8_bf16 v[100:115], v[80:81], v[68:69], v[100:115]
    v_exp_f32 v130, v130
    v_exp_f32 v131, v131
    v_exp_f32 v148, v148
    v_exp_f32 v149, v149
    v_smfmac_f32_32x32x32_bf16 v[164:179], v[96:99], v[124:131], v18
    ds_read_b128 v[88:91], v16 offset:17696
    v_exp_f32 v150, v150
    v_exp_f32 v151, v151
    v_exp_f32 v152, v152
    v_exp_f32 v153, v153
    v_mfma_f32_32x32x16_bf16 v[132:147], v[72:75], v[64:67], 0
    v_exp_f32 v154, v154
    v_exp_f32 v155, v155
    v_exp_f32 v156, v156
    v_exp_f32 v157, v157
    v_smfmac_f32_32x32x32_bf16 v[180:195], v[92:95], v[148:155], v18
    s_waitcnt lgkmcnt(1)
    v_exp_f32 v158, v158
    v_exp_f32 v159, v159
    v_exp_f32 v160, v160
    v_exp_f32 v161, v161
    v_mfma_f32_32x32x8_bf16 v[132:147], v[80:81], v[70:71], v[132:147]
    v_exp_f32 v162, v162
    v_exp_f32 v163, v163
    v_exp_f32 v100, v100
    v_exp_f32 v101, v101
    v_smfmac_f32_32x32x32_bf16 v[180:195], v[96:99], v[156:163], v18
    ds_read_b128 v[92:95], v16 offset:19648
    v_exp_f32 v102, v102
    v_exp_f32 v103, v103
    v_exp_f32 v104, v104
    v_exp_f32 v105, v105
    v_mfma_f32_32x32x16_bf16 v[116:131], v[76:79], v[60:63], 0
    ds_read_b128 v[72:75], v12 offset:20992
    v_exp_f32 v106, v106
    v_exp_f32 v107, v107
    v_exp_f32 v108, v108
    v_exp_f32 v109, v109
    v_smfmac_f32_32x32x32_bf16 v[164:179], v[84:87], v[100:107], v18
    s_waitcnt lgkmcnt(2)
    ds_read_b32 v80, v14 offset:22016
    v_exp_f32 v110, v110
    v_exp_f32 v111, v111
    v_exp_f32 v112, v112
    v_exp_f32 v113, v113
    v_mfma_f32_32x32x8_bf16 v[116:131], v[82:83], v[68:69], v[116:131]
    v_exp_f32 v114, v114
    v_exp_f32 v115, v115
    v_exp_f32 v132, v132
    v_exp_f32 v133, v133
    v_smfmac_f32_32x32x32_bf16 v[164:179], v[88:91], v[108:115], v18
    ds_read_b128 v[96:99], v16 offset:20320
    v_exp_f32 v134, v134
    v_exp_f32 v135, v135
    v_exp_f32 v136, v136
    v_exp_f32 v137, v137
    v_mfma_f32_32x32x16_bf16 v[148:163], v[76:79], v[64:67], 0
    v_exp_f32 v138, v138
    v_exp_f32 v139, v139
    v_exp_f32 v140, v140
    v_exp_f32 v141, v141
    v_smfmac_f32_32x32x32_bf16 v[180:195], v[84:87], v[132:139], v18
    s_waitcnt lgkmcnt(1)
    v_exp_f32 v142, v142
    v_exp_f32 v143, v143
    v_exp_f32 v144, v144
    v_exp_f32 v145, v145
    v_mfma_f32_32x32x8_bf16 v[148:163], v[82:83], v[70:71], v[148:163]
    v_exp_f32 v146, v146
    v_exp_f32 v147, v147
    v_exp_f32 v116, v116
    v_exp_f32 v117, v117
    v_smfmac_f32_32x32x32_bf16 v[180:195], v[88:91], v[140:147], v18
    ds_read_b128 v[84:87], v16 offset:22272
    v_exp_f32 v118, v118
    v_exp_f32 v119, v119
    v_exp_f32 v120, v120
    v_exp_f32 v121, v121
    v_mfma_f32_32x32x16_bf16 v[100:115], v[72:75], v[60:63], 0
    ds_read_b128 v[76:79], v12 offset:23616
    v_exp_f32 v122, v122
    v_exp_f32 v123, v123
    v_exp_f32 v124, v124
    v_exp_f32 v125, v125
    v_smfmac_f32_32x32x32_bf16 v[164:179], v[92:95], v[116:123], v18
    s_waitcnt lgkmcnt(2)
    ds_read_b32 v82, v14 offset:24640
    v_exp_f32 v126, v126
    v_exp_f32 v127, v127
    v_exp_f32 v128, v128
    v_exp_f32 v129, v129
    v_mfma_f32_32x32x8_bf16 v[100:115], v[80:81], v[68:69], v[100:115]
    v_exp_f32 v130, v130
    v_exp_f32 v131, v131
    v_exp_f32 v148, v148
    v_exp_f32 v149, v149
    v_smfmac_f32_32x32x32_bf16 v[164:179], v[96:99], v[124:131], v18
    ds_read_b128 v[88:91], v16 offset:22944
    v_exp_f32 v150, v150
    v_exp_f32 v151, v151
    v_exp_f32 v152, v152
    v_exp_f32 v153, v153
    v_mfma_f32_32x32x16_bf16 v[132:147], v[72:75], v[64:67], 0
    v_exp_f32 v154, v154
    v_exp_f32 v155, v155
    v_exp_f32 v156, v156
    v_exp_f32 v157, v157
    v_smfmac_f32_32x32x32_bf16 v[180:195], v[92:95], v[148:155], v18
    s_waitcnt lgkmcnt(1)
    v_exp_f32 v158, v158
    v_exp_f32 v159, v159
    v_exp_f32 v160, v160
    v_exp_f32 v161, v161
    v_mfma_f32_32x32x8_bf16 v[132:147], v[80:81], v[70:71], v[132:147]
    v_exp_f32 v162, v162
    v_exp_f32 v163, v163
    v_exp_f32 v100, v100
    v_exp_f32 v101, v101
    v_smfmac_f32_32x32x32_bf16 v[180:195], v[96:99], v[156:163], v18
    ds_read_b128 v[92:95], v16 offset:24896
    v_exp_f32 v102, v102
    v_exp_f32 v103, v103
    v_exp_f32 v104, v104
    v_exp_f32 v105, v105
    v_mfma_f32_32x32x16_bf16 v[116:131], v[76:79], v[60:63], 0
    ds_read_b128 v[72:75], v12 offset:26240
    v_exp_f32 v106, v106
    v_exp_f32 v107, v107
    v_exp_f32 v108, v108
    v_exp_f32 v109, v109
    v_smfmac_f32_32x32x32_bf16 v[164:179], v[84:87], v[100:107], v18
    s_waitcnt lgkmcnt(2)
    ds_read_b32 v80, v14 offset:27264
    v_exp_f32 v110, v110
    v_exp_f32 v111, v111
    v_exp_f32 v112, v112
    v_exp_f32 v113, v113
    v_mfma_f32_32x32x8_bf16 v[116:131], v[82:83], v[68:69], v[116:131]
    v_exp_f32 v114, v114
    v_exp_f32 v115, v115
    v_exp_f32 v132, v132
    v_exp_f32 v133, v133
    v_smfmac_f32_32x32x32_bf16 v[164:179], v[88:91], v[108:115], v18
    ds_read_b128 v[96:99], v16 offset:25568
    v_exp_f32 v134, v134
    v_exp_f32 v135, v135
    v_exp_f32 v136, v136
    v_exp_f32 v137, v137
    v_mfma_f32_32x32x16_bf16 v[148:163], v[76:79], v[64:67], 0
    v_exp_f32 v138, v138
    v_exp_f32 v139, v139
    v_exp_f32 v140, v140
    v_exp_f32 v141, v141
    v_smfmac_f32_32x32x32_bf16 v[180:195], v[84:87], v[132:139], v18
    s_waitcnt lgkmcnt(1)
    v_exp_f32 v142, v142
    v_exp_f32 v143, v143
    v_exp_f32 v144, v144
    v_exp_f32 v145, v145
    v_mfma_f32_32x32x8_bf16 v[148:163], v[82:83], v[70:71], v[148:163]
    v_exp_f32 v146, v146
    v_exp_f32 v147, v147
    v_exp_f32 v116, v116
    v_exp_f32 v117, v117
    v_smfmac_f32_32x32x32_bf16 v[180:195], v[88:91], v[140:147], v18
    ds_read_b128 v[84:87], v16 offset:27520
    v_exp_f32 v118, v118
    v_exp_f32 v119, v119
    v_exp_f32 v120, v120
    v_exp_f32 v121, v121
    v_mfma_f32_32x32x16_bf16 v[100:115], v[72:75], v[60:63], 0
    ds_read_b128 v[76:79], v12 offset:28864
    v_exp_f32 v122, v122
    v_exp_f32 v123, v123
    v_exp_f32 v124, v124
    v_exp_f32 v125, v125
    v_smfmac_f32_32x32x32_bf16 v[164:179], v[92:95], v[116:123], v18
    s_waitcnt lgkmcnt(2)
    ds_read_b32 v82, v14 offset:29888
    v_exp_f32 v126, v126
    v_exp_f32 v127, v127
    v_exp_f32 v128, v128
    v_exp_f32 v129, v129
    v_mfma_f32_32x32x8_bf16 v[100:115], v[80:81], v[68:69], v[100:115]
    v_exp_f32 v130, v130
    v_exp_f32 v131, v131
    v_exp_f32 v148, v148
    v_exp_f32 v149, v149
    v_smfmac_f32_32x32x32_bf16 v[164:179], v[96:99], v[124:131], v18
    ds_read_b128 v[88:91], v16 offset:28192
    v_exp_f32 v150, v150
    v_exp_f32 v151, v151
    v_exp_f32 v152, v152
    v_exp_f32 v153, v153
    v_mfma_f32_32x32x16_bf16 v[132:147], v[72:75], v[64:67], 0
    v_exp_f32 v154, v154
    v_exp_f32 v155, v155
    v_exp_f32 v156, v156
    v_exp_f32 v157, v157
    v_smfmac_f32_32x32x32_bf16 v[180:195], v[92:95], v[148:155], v18
    s_waitcnt lgkmcnt(1)
    s_cmp_eq_u32 s27, 3
    s_cbranch_scc1 L_bal
L_balr:
    v_exp_f32 v158, v158
    v_exp_f32 v159, v159
    v_exp_f32 v160, v160
    v_exp_f32 v161, v161
    v_mfma_f32_32x32x8_bf16 v[132:147], v[80:81], v[70:71], v[132:147]
    v_exp_f32 v162, v162
    v_exp_f32 v163, v163
    v_exp_f32 v100, v100
    v_exp_f32 v101, v101
    v_smfmac_f32_32x32x32_bf16 v[180:195], v[96:99], v[156:163], v18
    ds_read_b128 v[92:95], v16 offset:30144
    v_exp_f32 v102, v102
    v_exp_f32 v103, v103
    v_exp_f32 v104, v104
    v_exp_f32 v105, v105
    v_mfma_f32_32x32x16_bf16 v[116:131], v[76:79], v[60:63], 0
    ds_read_b128 v[72:75], v13 offset:0
    v_exp_f32 v106, v106
    v_exp_f32 v107, v107
    v_exp_f32 v108, v108
    v_exp_f32 v109, v109
    v_smfmac_f32_32x32x32_bf16 v[164:179], v[84:87], v[100:107], v18
    s_waitcnt lgkmcnt(2)
    ds_read_b32 v80, v15 offset:1024
    v_exp_f32 v110, v110
    v_exp_f32 v111, v111
    v_exp_f32 v112, v112
    v_exp_f32 v113, v113
    v_mfma_f32_32x32x8_bf16 v[116:131], v[82:83], v[68:69], v[116:131]
    v_exp_f32 v114, v114
    v_exp_f32 v115, v115
    v_exp_f32 v132, v132
    v_exp_f32 v133, v133
    v_smfmac_f32_32x32x32_bf16 v[164:179], v[88:91], v[108:115], v18
    ds_read_b128 v[96:99], v16 offset:30816
    v_exp_f32 v134, v134
    v_exp_f32 v135, v135
    v_exp_f32 v136, v136
    v_exp_f32 v137, v137
    v_mfma_f32_32x32x16_bf16 v[148:163], v[76:79], v[64:67], 0
    v_exp_f32 v138, v138
    v_exp_f32 v139, v139
    v_exp_f32 v140, v140
    v_exp_f32 v141, v141
    v_smfmac_f32_32x32x32_bf16 v[180:195], v[84:87], v[132:139], v18
    s_waitcnt lgkmcnt(1)
    v_exp_f32 v142, v142
    v_exp_f32 v143, v143
    v_exp_f32 v144, v144
    v_exp_f32 v145, v145
    v_mfma_f32_32x32x8_bf16 v[148:163], v[82:83], v[70:71], v[148:163]
    v_exp_f32 v146, v146
    v_exp_f32 v147, v147
    v_exp_f32 v116, v116
    v_exp_f32 v117, v117
    v_smfmac_f32_32x32x32_bf16 v[180:195], v[88:91], v[140:147], v18
    ds_read_b128 v[84:87], v17 offset:1280
    v_exp_f32 v118, v118
    v_exp_f32 v119, v119
    v_exp_f32 v120, v120
    v_exp_f32 v121, v121
    v_mfma_f32_32x32x16_bf16 v[100:115], v[72:75], v[60:63], 0
    ds_read_b128 v[76:79], v13 offset:2624
    v_exp_f32 v122, v122
    v_exp_f32 v123, v123
    v_exp_f32 v124, v124
    v_exp_f32 v125, v125
    v_smfmac_f32_32x32x32_bf16 v[164:179], v[92:95], v[116:123], v18
    s_waitcnt lgkmcnt(2)
    ds_read_b32 v82, v15 offset:3648
    v_exp_f32 v126, v126
    v_exp_f32 v127, v127
    v_exp_f32 v128, v128
    v_exp_f32 v129, v129
    v_mfma_f32_32x32x8_bf16 v[100:115], v[80:81], v[68:69], v[100:115]
    v_exp_f32 v130, v130
    v_exp_f32 v131, v131
    v_exp_f32 v148, v148
    v_exp_f32 v149, v149
    v_smfmac_f32_32x32x32_bf16 v[164:179], v[96:99], v[124:131], v18
    ds_read_b128 v[88:91], v17 offset:1952
    v_exp_f32 v150, v150
    v_exp_f32 v151, v151
    v_exp_f32 v152, v152
    v_exp_f32 v153, v153
    v_mfma_f32_32x32x16_bf16 v[132:147], v[72:75], v[64:67], 0
    v_exp_f32 v154, v154
    v_exp_f32 v155, v155
    v_exp_f32 v156, v156
    v_exp_f32 v157, v157
    v_smfmac_f32_32x32x32_bf16 v[180:195], v[92:95], v[148:155], v18
    s_waitcnt lgkmcnt(1)
    s_cmp_eq_u32 s27, 1
    s_cbranch_scc1 L_bal1
L_bal1r:
    v_exp_f32 v158, v158
    v_exp_f32 v159, v159
    v_exp_f32 v160, v160
    v_exp_f32 v161, v161
    v_mfma_f32_32x32x8_bf16 v[132:147], v[80:81], v[70:71], v[132:147]
    v_exp_f32 v162, v162
    v_exp_f32 v163, v163
    v_exp_f32 v100, v100
    v_exp_f32 v101, v101
    v_smfmac_f32_32x32x32_bf16 v[180:195], v[96:99], v[156:163], v18
    ds_read_b128 v[92:95], v17 offset:3904
    v_exp_f32 v102, v102
    v_exp_f32 v103, v103
    v_exp_f32 v104, v104
    v_exp_f32 v105, v105
    v_mfma_f32_32x32x16_bf16 v[116:131], v[76:79], v[60:63], 0
    ds_read_b128 v[72:75], v13 offset:5248
    v_exp_f32 v106, v106
    v_exp_f32 v107, v107
    v_exp_f32 v108, v108
    v_exp_f32 v109, v109
    v_smfmac_f32_32x32x32_bf16 v[164:179], v[84:87], v[100:107], v18
    s_waitcnt lgkmcnt(2)
    ds_read_b32 v80, v15 offset:6272
    v_exp_f32 v110, v110
    v_exp_f32 v111, v111
    v_exp_f32 v112, v112
    v_exp_f32 v113, v113
    v_mfma_f32_32x32x8_bf16 v[116:131], v[82:83], v[68:69], v[116:131]
    v_exp_f32 v114, v114
    v_exp_f32 v115, v115
    v_exp_f32 v132, v132
    v_exp_f32 v133, v133
    v_smfmac_f32_32x32x32_bf16 v[164:179], v[88:91], v[108:115], v18
    ds_read_b128 v[96:99], v17 offset:4576
    v_exp_f32 v134, v134
    v_exp_f32 v135, v135
    v_exp_f32 v136, v136
    v_exp_f32 v137, v137
    v_mfma_f32_32x32x16_bf16 v[148:163], v[76:79], v[64:67], 0
    v_exp_f32 v138, v138
    v_exp_f32 v139, v139
    v_exp_f32 v140, v140
    v_exp_f32 v141, v141
    v_smfmac_f32_32x32x32_bf16 v[180:195], v[84:87], v[132:139], v18
    s_waitcnt lgkmcnt(1)
    v_exp_f32 v142, v142
    v_exp_f32 v143, v143
    v_exp_f32 v144, v144
    v_exp_f32 v145, v145
    v_mfma_f32_32x32x8_bf16 v[148:163], v[82:83], v[70:71], v[148:163]
    v_exp_f32 v146, v146
    v_exp_f32 v147, v147
    v_exp_f32 v116, v116
    v_exp_f32 v117, v117
    v_smfmac_f32_32x32x32_bf16 v[180:195], v[88:91], v[140:147], v18
    ds_read_b128 v[84:87], v17 offset:6528
    v_exp_f32 v118, v118
    v_exp_f32 v119, v119
    v_exp_f32 v120, v120
    v_exp_f32 v121, v121
    v_mfma_f32_32x32x16_bf16 v[100:115], v[72:75], v[60:63], 0
    ds_read_b128 v[76:79], v13 offset:7872
    v_exp_f32 v122, v122
    v_exp_f32 v123, v123
    v_exp_f32 v124, v124
    v_exp_f32 v125, v125
    v_smfmac_f32_32x32x32_bf16 v[164:179], v[92:95], v[116:123], v18
    s_waitcnt lgkmcnt(2)
    ds_read_b32 v82, v15 offset:8896
    v_exp_f32 v126, v126
    v_exp_f32 v127, v127
    v_exp_f32 v128, v128
    v_exp_f32 v129, v129
    v_mfma_f32_32x32x8_bf16 v[100:115], v[80:81], v[68:69], v[100:115]
    v_exp_f32 v130, v130
    v_exp_f32 v131, v131
    v_exp_f32 v148, v148
    v_exp_f32 v149, v149
    v_smfmac_f32_32x32x32_bf16 v[164:179], v[96:99], v[124:131], v18
    ds_read_b128 v[88:91], v17 offset:7200
    v_exp_f32 v150, v150
    v_exp_f32 v151, v151
    v_exp_f32 v152, v152
    v_exp_f32 v153, v153
    v_mfma_f32_32x32x16_bf16 v[132:147], v[72:75], v[64:67], 0
    v_exp_f32 v154, v154
    v_exp_f32 v155, v155
    v_exp_f32 v156, v156
    v_exp_f32 v157, v157
    v_smfmac_f32_32x32x32_bf16 v[180:195], v[92:95], v[148:155], v18
    s_waitcnt lgkmcnt(1)
    v_exp_f32 v158, v158
    v_exp_f32 v159, v159
    v_exp_f32 v160, v160
    v_exp_f32 v161, v161
    v_mfma_f32_32x32x8_bf16 v[132:147], v[80:81], v[70:71], v[132:147]
    v_exp_f32 v162, v162
    v_exp_f32 v163, v163
    v_exp_f32 v100, v100
    v_exp_f32 v101, v101
    v_smfmac_f32_32x32x32_bf16 v[180:195], v[96:99], v[156:163], v18
    ds_read_b128 v[92:95], v17 offset:9152
    v_exp_f32 v102, v102
    v_exp_f32 v103, v103
    v_exp_f32 v104, v104
    v_exp_f32 v105, v105
    v_mfma_f32_32x32x16_bf16 v[116:131], v[76:79], v[60:63], 0
    ds_read_b128 v[72:75], v12 offset:41984
    v_exp_f32 v106, v106
    v_exp_f32 v107, v107
    v_exp_f32 v108, v108
    v_exp_f32 v109, v109
    v_smfmac_f32_32x32x32_bf16 v[164:179], v[84:87], v[100:107], v18
    s_waitcnt lgkmcnt(2)
    ds_read_b32 v80, v14 offset:43008
    v_exp_f32 v110, v110
    v_exp_f32 v111, v111
    v_exp_f32 v112, v112
    v_exp_f32 v113, v113
    v_mfma_f32_32x32x8_bf16 v[116:131], v[82:83], v[68:69], v[116:131]
    v_exp_f32 v114, v114
    v_exp_f32 v115, v115
    v_exp_f32 v132, v132
    v_exp_f32 v133, v133
    v_smfmac_f32_32x32x32_bf16 v[164:179], v[88:91], v[108:115], v18
    ds_read_b128 v[96:99], v17 offset:9824
    v_exp_f32 v134, v134
    v_exp_f32 v135, v135
    v_exp_f32 v136, v136
    v_exp_f32 v137, v137
    v_mfma_f32_32x32x16_bf16 v[148:163], v[76:79], v[64:67], 0
    v_exp_f32 v138, v138
    v_exp_f32 v139, v139
    v_exp_f32 v140, v140
    v_exp_f32 v141, v141
    v_smfmac_f32_32x32x32_bf16 v[180:195], v[84:87], v[132:139], v18
    s_waitcnt lgkmcnt(1)
    v_exp_f32 v142, v142
    v_exp_f32 v143, v143
    v_exp_f32 v144, v144
    v_exp_f32 v145, v145
    v_mfma_f32_32x32x8_bf16 v[148:163], v[82:83], v[70:71], v[148:163]
    v_exp_f32 v146, v146
    v_exp_f32 v147, v147
    v_exp_f32 v116, v116
    v_exp_f32 v117, v117
    v_smfmac_f32_32x32x32_bf16 v[180:195], v[88:91], v[140:147], v18
    ds_read_b128 v[84:87], v16 offset:43264
    v_exp_f32 v118, v118
    v_exp_f32 v119, v119
    v_exp_f32 v120, v120
    v_exp_f32 v121, v121
    v_mfma_f32_32x32x16_bf16 v[100:115], v[72:75], v[60:63], 0
    ds_read_b128 v[76:79], v12 offset:44608
    v_exp_f32 v122, v122
    v_exp_f32 v123, v123
    v_exp_f32 v124, v124
    v_exp_f32 v125, v125
    v_smfmac_f32_32x32x32_bf16 v[164:179], v[92:95], v[116:123], v18
    s_waitcnt lgkmcnt(2)
    ds_read_b32 v82, v14 offset:45632
    v_exp_f32 v126, v126
    v_exp_f32 v127, v127
    v_exp_f32 v128, v128
    v_exp_f32 v129, v129
    v_mfma_f32_32x32x8_bf16 v[100:115], v[80:81], v[68:69], v[100:115]
    v_exp_f32 v130, v130
    v_exp_f32 v131, v131
    v_exp_f32 v148, v148
    v_exp_f32 v149, v149
    v_smfmac_f32_32x32x32_bf16 v[164:179], v[96:99], v[124:131], v18
    ds_read_b128 v[88:91], v16 offset:43936
    v_exp_f32 v150, v150
    v_exp_f32 v151, v151
    v_exp_f32 v152, v152
    v_exp_f32 v153, v153
    v_mfma_f32_32x32x16_bf16 v[132:147], v[72:75], v[64:67], 0
    s_add_u32 s27, s27, 1
    v_exp_f32 v154, v154
    v_exp_f32 v155, v155
    v_exp_f32 v156, v156
    v_exp_f32 v157, v157
    v_smfmac_f32_32x32x32_bf16 v[180:195], v[92:95], v[148:155], v18
    s_waitcnt lgkmcnt(1)
    v_exp_f32 v158, v158
    v_exp_f32 v159, v159
    v_exp_f32 v160, v160
    v_exp_f32 v161, v161
    v_mfma_f32_32x32x8_bf16 v[132:147], v[80:81], v[70:71], v[132:147]
    v_exp_f32 v162, v162
    v_exp_f32 v163, v163
    s_cmp_eq_u32 s27, 4
    s_cbranch_scc1 L_adone
    v_add_u32 v12, 41984, v12
    v_add_u32 v14, 41984, v14
    v_add_u32 v16, 41984, v16
    s_cmp_eq_u32 s27, 3
    s_mov_b32 s23, 41984
    s_cmov_b32 s23, 4294851840
    v_add_u32 v13, s23, v13
    v_add_u32 v15, s23, v15
    v_add_u32 v17, s23, v17
    s_cmp_lg_u32 s27, 2
    s_cbranch_scc1 L_loop
    s_waitcnt vmcnt(0)
    s_barrier
    s_setprio 1
    s_cmp_eq_u32 s38, 0
    s_cbranch_scc1 L_wpf
    s_setprio 2
    s_branch L_loop
L_adone:
    s_setprio 3
    s_waitcnt lgkmcnt(0)
    v_smfmac_f32_32x32x32_bf16 v[180:195], v[96:99], v[156:163], v18
    v_mov_b32 v177, v176
    s_nop 1
    v_permlane32_swap_b32 v176, v177
    s_nop 1
    v_mov_b32 v2, v176
    v_fma_f32 v2, v164, 0, v2
    v_fma_f32 v2, v165, 0, v2
    v_fma_f32 v2, v166, 0, v2
    v_fma_f32 v2, v167, 0, v2
    v_fma_f32 v2, v168, 0, v2
    v_fma_f32 v2, v169, 0, v2
    v_fma_f32 v2, v170, 0, v2
    v_fma_f32 v2, v171, 0, v2
    v_fma_f32 v2, v172, 0, v2
    v_fma_f32 v2, v173, 0, v2
    v_fma_f32 v2, v174, 0, v2
    v_fma_f32 v2, v175, 0, v2
    v_mov_b32 v193, v192
    s_nop 1
    v_permlane32_swap_b32 v192, v193
    s_nop 1
    v_mov_b32 v3, v192
    v_fma_f32 v3, v180, 0, v3
    v_fma_f32 v3, v181, 0, v3
    v_fma_f32 v3, v182, 0, v3
    v_fma_f32 v3, v183, 0, v3
    v_fma_f32 v3, v184, 0, v3
    v_fma_f32 v3, v185, 0, v3
    v_fma_f32 v3, v186, 0, v3
    v_fma_f32 v3, v187, 0, v3
    v_fma_f32 v3, v188, 0, v3
    v_fma_f32 v3, v189, 0, v3
    v_fma_f32 v3, v190, 0, v3
    v_fma_f32 v3, v191, 0, v3
    v_cmp_le_f32 vcc, 0x2b800000, v2
    s_mov_b64 s[44:45], vcc
    v_cmp_le_f32 vcc, 0x2b800000, v3
    s_and_b64 s[44:45], s[44:45], vcc
    v_cmp_ge_f32 vcc, 0x5d800000, v2
    s_and_b64 s[44:45], s[44:45], vcc
    v_cmp_ge_f32 vcc, 0x5d800000, v3
    s_and_b64 s[44:45], s[44:45], vcc
    s_cmp_eq_u64 s[44:45], -1
    s_cbranch_scc0 L_fallback
L_store:
    v_rcp_f32 v24, v176
    v_rcp_f32 v26, v192
    v_mov_b32 v25, v24
    v_mov_b32 v27, v26
    v_pk_mul_f32 v[164:165], v[164:165], v[24:25]
    v_pk_mul_f32 v[166:167], v[166:167], v[24:25]
    v_pk_mul_f32 v[168:169], v[168:169], v[24:25]
    v_pk_mul_f32 v[170:171], v[170:171], v[24:25]
    v_pk_mul_f32 v[172:173], v[172:173], v[24:25]
    v_pk_mul_f32 v[174:175], v[174:175], v[24:25]
    v_cvt_pk_bf16_f32 v100, v164, v165
    v_cvt_pk_bf16_f32 v101, v166, v167
    v_cvt_pk_bf16_f32 v102, v168, v169
    v_cvt_pk_bf16_f32 v103, v170, v171
    v_cvt_pk_bf16_f32 v104, v172, v173
    v_cvt_pk_bf16_f32 v105, v174, v175
    buffer_store_dwordx4 v[100:103], v22, s[16:19], 0 offen offset:0 sc1
    buffer_store_dwordx2 v[104:105], v23, s[16:19], 0 offen offset:0 sc1
    v_pk_mul_f32 v[180:181], v[180:181], v[26:27]
    v_pk_mul_f32 v[182:183], v[182:183], v[26:27]
    v_pk_mul_f32 v[184:185], v[184:185], v[26:27]
    v_pk_mul_f32 v[186:187], v[186:187], v[26:27]
    v_pk_mul_f32 v[188:189], v[188:189], v[26:27]
    v_pk_mul_f32 v[190:191], v[190:191], v[26:27]
    v_cvt_pk_bf16_f32 v132, v180, v181
    v_cvt_pk_bf16_f32 v133, v182, v183
    v_cvt_pk_bf16_f32 v134, v184, v185
    v_cvt_pk_bf16_f32 v135, v186, v187
    v_cvt_pk_bf16_f32 v136, v188, v189
    v_cvt_pk_bf16_f32 v137, v190, v191
    buffer_store_dwordx4 v[132:135], v22, s[16:19], 0 offen offset:512 sc1
    buffer_store_dwordx2 v[136:137], v23, s[16:19], 0 offen offset:256 sc1
    s_mul_i32 s23, s37, 2621696
    s_add_u32 s23, s23, 10797184
    s_add_u32 s8, s84, s23
    s_addc_u32 s9, s85, 0
    s_mov_b32 s10, 2621696
    s_mov_b32 s11, 0x00020000
    s_mov_b32 s35, 0
    s_mov_b32 s43, 1000000
    s_barrier
    s_cmp_ge_u32 s20, 6
    s_cbranch_scc1 L_ow4
    s_cmp_ge_u32 s20, 4
    s_cbranch_scc1 L_ow2
    s_mul_i32 s23, s20, 5120
    s_add_u32 s23, s23, 81920
    s_mul_i32 s24, s20, 204800
    s_add_u32 m0, s23, 10496
    s_nop 0
    buffer_load_dwordx4 v201, s[92:95], s24 offen lds
    s_add_u32 m0, s23, 11520
    s_nop 0
    buffer_load_dwordx4 v202, s[92:95], s24 offen lds
    s_add_u32 m0, s23, 12544
    s_nop 0
    buffer_load_dwordx4 v203, s[92:95], s24 offen lds
    s_add_u32 m0, s23, 13568
    s_nop 0
    buffer_load_dwordx4 v204, s[92:95], s24 offen lds
    s_add_u32 m0, s23, 14592
    s_nop 0
    buffer_load_dwordx4 v205, s[92:95], s24 offen lds
    s_branch L_ow3
L_ow2:
    s_add_u32 s25, s20, 10
    s_mul_i32 s23, s25, 5120
    s_mul_i32 s24, s25, 51200
    s_add_u32 m0, s23, 10496
    s_nop 0
    buffer_load_dwordx4 v196, s[92:95], s24 offen lds
    s_add_u32 m0, s23, 11520
    s_nop 0
    buffer_load_dwordx4 v197, s[92:95], s24 offen lds
    s_add_u32 m0, s23, 12544
    s_nop 0
    buffer_load_dwordx4 v198, s[92:95], s24 offen lds
    s_add_u32 m0, s23, 13568
    s_nop 0
    buffer_load_dwordx4 v199, s[92:95], s24 offen lds
    s_add_u32 m0, s23, 14592
    s_nop 0
    buffer_load_dwordx4 v200, s[92:95], s24 offen lds
L_ow3:
    s_waitcnt vmcnt(5)
    s_branch L_ow5
L_ow4:
    s_waitcnt vmcnt(0)
L_ow5:
    s_barrier
    s_cmp_lg_u32 s20, 7
    s_cbranch_scc1 L_nf3
    v_lshl_add_u32 v2, v1, 11, s32
    v_mov_b32 v4, s86
    v_mov_b32 v5, s87
    s_mov_b32 exec_lo, 255
    s_mov_b32 exec_hi, 0
    global_store_dwordx2 v2, v[4:5], s[84:85] sc1
    s_mov_b64 exec, -1
L_tp:
    global_load_dwordx2 v[10:11], v208, s[84:85] sc1
    s_waitcnt vmcnt(0)
    v_cmp_eq_u64 vcc, s[86:87], v[10:11]
    s_sub_u32 s43, s43, 1
    s_cselect_b32 vcc_lo, -1, vcc_lo
    s_lshr_b32 s23, vcc_lo, 1
    s_and_b32 s23, s23, vcc_lo
    s_lshr_b32 s24, s23, 2
    s_and_b32 s23, s23, s24
    s_and_b32 s36, s23, 0x11111111
    s_bcnt1_i32_b32 s23, s36
    s_cmp_lt_u32 s23, 2
    s_cbranch_scc1 L_tp
    v_mov_b32 v2, 163808
    v_mov_b32 v3, s36
    ds_write_b32 v2, v3
L_nf3:
    s_mul_i32 s23, s40, 2560
    s_mul_i32 s24, s37, 1280
    s_add_u32 s23, s23, s24
    s_mul_i32 s24, s34, 160
    s_add_u32 s23, s23, s24
    s_sub_u32 s24, 5242880, s23
    s_add_u32 s16, s80, s23
    s_addc_u32 s17, s81, 0
    s_mov_b32 s18, s24
    s_mov_b32 s19, 0x00020000
    v_mov_b32 v2, 163808
    s_waitcnt vmcnt(0) lgkmcnt(0)
    s_barrier
    ds_read_b32 v3, v2
    s_waitcnt lgkmcnt(0)
    v_readfirstlane_b32 s36, v3
    s_nop 3
    s_andn2_b32 s23, s36, s35
    s_cbranch_scc1 L_is0
L_ip0:
    global_load_dwordx2 v[10:11], v208, s[84:85] sc1
    s_waitcnt vmcnt(0)
    v_cmp_eq_u64 vcc, s[86:87], v[10:11]
    s_sub_u32 s43, s43, 1
    s_cselect_b32 vcc_lo, -1, vcc_lo
    s_lshr_b32 s23, vcc_lo, 1
    s_and_b32 s23, s23, vcc_lo
    s_lshr_b32 s24, s23, 2
    s_and_b32 s23, s23, s24
    s_and_b32 s36, s23, 0x11111111
    s_andn2_b32 s23, s36, s35
    s_cbranch_scc0 L_ip0
L_is0:
    s_ff1_i32_b32 s3, s23
    s_bitset1_b32 s35, s3
    s_lshl_b32 s23, s3, 16
    s_add_u32 s24, s23, 131072
    s_lshl_b32 s25, s3, 14
    s_add_u32 s25, s25, 2097280
    buffer_load_dwordx2 v[76:77], v207, s[8:11], s25 offen sc1
    buffer_load_dwordx4 v[12:15], v206, s[8:11], s23 offen sc1
    buffer_load_dwordx4 v[16:19], v206, s[8:11], s24 offen sc1
    s_andn2_b32 s23, s36, s35
    s_cbranch_scc1 L_is1
L_ip1:
    global_load_dwordx2 v[10:11], v208, s[84:85] sc1
    s_waitcnt vmcnt(0)
    v_cmp_eq_u64 vcc, s[86:87], v[10:11]
    s_sub_u32 s43, s43, 1
    s_cselect_b32 vcc_lo, -1, vcc_lo
    s_lshr_b32 s23, vcc_lo, 1
    s_and_b32 s23, s23, vcc_lo
    s_lshr_b32 s24, s23, 2
    s_and_b32 s23, s23, s24
    s_and_b32 s36, s23, 0x11111111
    s_andn2_b32 s23, s36, s35
    s_cbranch_scc0 L_ip1
L_is1:
    s_ff1_i32_b32 s4, s23
    s_bitset1_b32 s35, s4
    s_lshl_b32 s23, s4, 16
    s_add_u32 s24, s23, 131072
    s_lshl_b32 s25, s4, 14
    s_add_u32 s25, s25, 2097280
    buffer_load_dwordx2 v[78:79], v207, s[8:11], s25 offen sc1
    buffer_load_dwordx4 v[20:23], v206, s[8:11], s23 offen sc1
    buffer_load_dwordx4 v[24:27], v206, s[8:11], s24 offen sc1
    s_andn2_b32 s23, s36, s35
    s_cbranch_scc1 L_is2
L_ip2:
    global_load_dwordx2 v[10:11], v208, s[84:85] sc1
    s_waitcnt vmcnt(0)
    v_cmp_eq_u64 vcc, s[86:87], v[10:11]
    s_sub_u32 s43, s43, 1
    s_cselect_b32 vcc_lo, -1, vcc_lo
    s_lshr_b32 s23, vcc_lo, 1
    s_and_b32 s23, s23, vcc_lo
    s_lshr_b32 s24, s23, 2
    s_and_b32 s23, s23, s24
    s_and_b32 s36, s23, 0x11111111
    s_andn2_b32 s23, s36, s35
    s_cbranch_scc0 L_ip2
L_is2:
    s_ff1_i32_b32 s5, s23
    s_bitset1_b32 s35, s5
    s_lshl_b32 s23, s5, 16
    s_add_u32 s24, s23, 131072
    s_lshl_b32 s25, s5, 14
    s_add_u32 s25, s25, 2097280
    buffer_load_dwordx2 v[80:81], v207, s[8:11], s25 offen sc1
    buffer_load_dwordx4 v[28:31], v206, s[8:11], s23 offen sc1
    buffer_load_dwordx4 v[32:35], v206, s[8:11], s24 offen sc1
    s_mul_i32 s23, s3, 2560
    s_mul_i32 s24, s3, 640
    s_add_u32 s24, s24, 81920
    v_add_u32 v209, s23, v210
    v_add_u32 v211, s24, v210
    ds_read_b64_tr_b16 v[172:173], v211 offset:0
    ds_read_b64_tr_b16 v[176:177], v211 offset:32
    ds_read_b64_tr_b16 v[180:181], v211 offset:64
    ds_read_b64_tr_b16 v[184:185], v211 offset:96
    ds_read_b64_tr_b16 v[188:189], v211 offset:128
    ds_read_b64_tr_b16 v[92:93], v209 offset:0
    ds_read_b64_tr_b16 v[94:95], v209 offset:2560
    ds_read_b64_tr_b16 v[96:97], v209 offset:32
    ds_read_b64_tr_b16 v[98:99], v209 offset:2592
    ds_read_b64_tr_b16 v[100:101], v209 offset:64
    ds_read_b64_tr_b16 v[102:103], v209 offset:2624
    ds_read_b64_tr_b16 v[104:105], v209 offset:96
    s_waitcnt lgkmcnt(4)
    ds_read_b64_tr_b16 v[106:107], v209 offset:2656
    ds_read_b64_tr_b16 v[108:109], v209 offset:128
    ds_read_b64_tr_b16 v[110:111], v209 offset:2688
    ds_read_b64_tr_b16 v[112:113], v209 offset:5120
    ds_read_b64_tr_b16 v[114:115], v209 offset:7680
    ds_read_b64_tr_b16 v[116:117], v209 offset:5152
    ds_read_b64_tr_b16 v[118:119], v209 offset:7712
    ds_read_b64_tr_b16 v[120:121], v209 offset:5184
    s_waitcnt lgkmcnt(4)
    ds_read_b64_tr_b16 v[122:123], v209 offset:7744
    ds_read_b64_tr_b16 v[124:125], v209 offset:5216
    ds_read_b64_tr_b16 v[126:127], v209 offset:7776
    ds_read_b64_tr_b16 v[128:129], v209 offset:5248
    ds_read_b64_tr_b16 v[130:131], v209 offset:7808
    s_waitcnt vmcnt(6) lgkmcnt(0)
    s_mul_i32 s23, s4, 2560
    s_mul_i32 s24, s4, 640
    s_add_u32 s24, s24, 81920
    v_add_u32 v209, s23, v210
    v_add_u32 v211, s24, v210
    v_mfma_f32_16x16x32_bf16 v[228:231], v[92:95], v[12:15], 0
    ds_read_b64_tr_b16 v[132:133], v209 offset:0
    ds_read_b64_tr_b16 v[134:135], v209 offset:2560
    ds_read_b64_tr_b16 v[136:137], v209 offset:32
    v_mfma_f32_16x16x32_bf16 v[232:235], v[96:99], v[12:15], 0
    ds_read_b64_tr_b16 v[138:139], v209 offset:2592
    ds_read_b64_tr_b16 v[140:141], v209 offset:64
    ds_read_b64_tr_b16 v[142:143], v209 offset:2624
    v_mfma_f32_16x16x32_bf16 v[236:239], v[100:103], v[12:15], 0
    ds_read_b64_tr_b16 v[144:145], v209 offset:96
    ds_read_b64_tr_b16 v[146:147], v209 offset:2656
    ds_read_b64_tr_b16 v[148:149], v209 offset:128
    v_mfma_f32_16x16x32_bf16 v[240:243], v[104:107], v[12:15], 0
    ds_read_b64_tr_b16 v[150:151], v209 offset:2688
    ds_read_b64_tr_b16 v[152:153], v209 offset:5120
    ds_read_b64_tr_b16 v[154:155], v209 offset:7680
    v_mfma_f32_16x16x32_bf16 v[244:247], v[108:111], v[12:15], 0
    s_waitcnt lgkmcnt(3)
    ds_read_b64_tr_b16 v[156:157], v209 offset:5152
    ds_read_b64_tr_b16 v[158:159], v209 offset:7712
    ds_read_b64_tr_b16 v[160:161], v209 offset:5184
    v_mfma_f32_16x16x32_bf16 v[228:231], v[112:115], v[16:19], v[228:231]
    ds_read_b64_tr_b16 v[162:163], v209 offset:7744
    ds_read_b64_tr_b16 v[164:165], v209 offset:5216
    ds_read_b64_tr_b16 v[166:167], v209 offset:7776
    v_mfma_f32_16x16x32_bf16 v[232:235], v[116:119], v[16:19], v[232:235]
    ds_read_b64_tr_b16 v[168:169], v209 offset:5248
    ds_read_b64_tr_b16 v[170:171], v209 offset:7808
    ds_read_b64_tr_b16 v[174:175], v211 offset:0
    v_mfma_f32_16x16x32_bf16 v[236:239], v[120:123], v[16:19], v[236:239]
    s_waitcnt lgkmcnt(3)
    ds_read_b64_tr_b16 v[178:179], v211 offset:32
    ds_read_b64_tr_b16 v[182:183], v211 offset:64
    ds_read_b64_tr_b16 v[186:187], v211 offset:96
    v_mfma_f32_16x16x32_bf16 v[240:243], v[124:127], v[16:19], v[240:243]
    ds_read_b64_tr_b16 v[190:191], v211 offset:128
    v_mfma_f32_16x16x32_bf16 v[244:247], v[128:131], v[16:19], v[244:247]
    s_andn2_b32 s23, s36, s35
    s_cbranch_scc1 L_is3
L_ip3:
    global_load_dwordx2 v[10:11], v208, s[84:85] sc1
    s_waitcnt vmcnt(0)
    v_cmp_eq_u64 vcc, s[86:87], v[10:11]
    s_sub_u32 s43, s43, 1
    s_cselect_b32 vcc_lo, -1, vcc_lo
    s_lshr_b32 s23, vcc_lo, 1
    s_and_b32 s23, s23, vcc_lo
    s_lshr_b32 s24, s23, 2
    s_and_b32 s23, s23, s24
    s_and_b32 s36, s23, 0x11111111
    s_andn2_b32 s23, s36, s35
    s_cbranch_scc0 L_ip3
L_is3:
    s_ff1_i32_b32 s6, s23
    s_bitset1_b32 s35, s6
    s_lshl_b32 s23, s6, 16
    s_add_u32 s24, s23, 131072
    s_lshl_b32 s25, s6, 14
    s_add_u32 s25, s25, 2097280
    buffer_load_dwordx2 v[82:83], v207, s[8:11], s25 offen sc1
    buffer_load_dwordx4 v[36:39], v206, s[8:11], s23 offen sc1
    buffer_load_dwordx4 v[40:43], v206, s[8:11], s24 offen sc1
    s_waitcnt vmcnt(6) lgkmcnt(0)
    s_mul_i32 s23, s5, 2560
    s_mul_i32 s24, s5, 640
    s_add_u32 s24, s24, 81920
    v_add_u32 v209, s23, v210
    v_add_u32 v211, s24, v210
    v_mfma_f32_16x16x32_bf16 v[228:231], v[172:175], v[76:79], v[228:231]
    ds_read_b64_tr_b16 v[92:93], v209 offset:0
    ds_read_b64_tr_b16 v[94:95], v209 offset:2560
    v_mfma_f32_16x16x32_bf16 v[232:235], v[176:179], v[76:79], v[232:235]
    ds_read_b64_tr_b16 v[96:97], v209 offset:32
    ds_read_b64_tr_b16 v[98:99], v209 offset:2592
    v_mfma_f32_16x16x32_bf16 v[236:239], v[180:183], v[76:79], v[236:239]
    ds_read_b64_tr_b16 v[100:101], v209 offset:64
    ds_read_b64_tr_b16 v[102:103], v209 offset:2624
    v_mfma_f32_16x16x32_bf16 v[240:243], v[184:187], v[76:79], v[240:243]
    ds_read_b64_tr_b16 v[104:105], v209 offset:96
    ds_read_b64_tr_b16 v[106:107], v209 offset:2656
    v_mfma_f32_16x16x32_bf16 v[244:247], v[188:191], v[76:79], v[244:247]
    ds_read_b64_tr_b16 v[108:109], v209 offset:128
    ds_read_b64_tr_b16 v[110:111], v209 offset:2688
    v_mfma_f32_16x16x32_bf16 v[228:231], v[132:135], v[20:23], v[228:231]
    ds_read_b64_tr_b16 v[112:113], v209 offset:5120
    ds_read_b64_tr_b16 v[114:115], v209 offset:7680
    v_mfma_f32_16x16x32_bf16 v[232:235], v[136:139], v[20:23], v[232:235]
    s_waitcnt lgkmcnt(3)
    ds_read_b64_tr_b16 v[116:117], v209 offset:5152
    ds_read_b64_tr_b16 v[118:119], v209 offset:7712
    v_mfma_f32_16x16x32_bf16 v[236:239], v[140:143], v[20:23], v[236:239]
    ds_read_b64_tr_b16 v[120:121], v209 offset:5184
    ds_read_b64_tr_b16 v[122:123], v209 offset:7744
    v_mfma_f32_16x16x32_bf16 v[240:243], v[144:147], v[20:23], v[240:243]
    ds_read_b64_tr_b16 v[124:125], v209 offset:5216
    ds_read_b64_tr_b16 v[126:127], v209 offset:7776
    v_mfma_f32_16x16x32_bf16 v[244:247], v[148:151], v[20:23], v[244:247]
    ds_read_b64_tr_b16 v[128:129], v209 offset:5248
    ds_read_b64_tr_b16 v[130:131], v209 offset:7808
    v_mfma_f32_16x16x32_bf16 v[228:231], v[152:155], v[24:27], v[228:231]
    s_waitcnt lgkmcnt(3)
    ds_read_b64_tr_b16 v[172:173], v211 offset:0
    ds_read_b64_tr_b16 v[176:177], v211 offset:32
    v_mfma_f32_16x16x32_bf16 v[232:235], v[156:159], v[24:27], v[232:235]
    ds_read_b64_tr_b16 v[180:181], v211 offset:64
    ds_read_b64_tr_b16 v[184:185], v211 offset:96
    v_mfma_f32_16x16x32_bf16 v[236:239], v[160:163], v[24:27], v[236:239]
    ds_read_b64_tr_b16 v[188:189], v211 offset:128
    v_mfma_f32_16x16x32_bf16 v[240:243], v[164:167], v[24:27], v[240:243]
    v_mfma_f32_16x16x32_bf16 v[244:247], v[168:171], v[24:27], v[244:247]
    s_andn2_b32 s23, s36, s35
    s_cbranch_scc1 L_is4
L_ip4:
    global_load_dwordx2 v[10:11], v208, s[84:85] sc1
    s_waitcnt vmcnt(0)
    v_cmp_eq_u64 vcc, s[86:87], v[10:11]
    s_sub_u32 s43, s43, 1
    s_cselect_b32 vcc_lo, -1, vcc_lo
    s_lshr_b32 s23, vcc_lo, 1
    s_and_b32 s23, s23, vcc_lo
    s_lshr_b32 s24, s23, 2
    s_and_b32 s23, s23, s24
    s_and_b32 s36, s23, 0x11111111
    s_andn2_b32 s23, s36, s35
    s_cbranch_scc0 L_ip4
L_is4:
    s_ff1_i32_b32 s7, s23
    s_bitset1_b32 s35, s7
    s_lshl_b32 s23, s7, 16
    s_add_u32 s24, s23, 131072
    s_lshl_b32 s25, s7, 14
    s_add_u32 s25, s25, 2097280
    buffer_load_dwordx2 v[84:85], v207, s[8:11], s25 offen sc1
    buffer_load_dwordx4 v[44:47], v206, s[8:11], s23 offen sc1
    buffer_load_dwordx4 v[48:51], v206, s[8:11], s24 offen sc1
    s_waitcnt vmcnt(6) lgkmcnt(0)
    s_mul_i32 s23, s6, 2560
    s_mul_i32 s24, s6, 640
    s_add_u32 s24, s24, 81920
    v_add_u32 v209, s23, v210
    v_add_u32 v211, s24, v210
    v_mfma_f32_16x16x32_bf16 v[228:231], v[92:95], v[28:31], v[228:231]
    ds_read_b64_tr_b16 v[132:133], v209 offset:0
    ds_read_b64_tr_b16 v[134:135], v209 offset:2560
    ds_read_b64_tr_b16 v[136:137], v209 offset:32
    v_mfma_f32_16x16x32_bf16 v[232:235], v[96:99], v[28:31], v[232:235]
    ds_read_b64_tr_b16 v[138:139], v209 offset:2592
    ds_read_b64_tr_b16 v[140:141], v209 offset:64
    ds_read_b64_tr_b16 v[142:143], v209 offset:2624
    v_mfma_f32_16x16x32_bf16 v[236:239], v[100:103], v[28:31], v[236:239]
    ds_read_b64_tr_b16 v[144:145], v209 offset:96
    ds_read_b64_tr_b16 v[146:147], v209 offset:2656
    ds_read_b64_tr_b16 v[148:149], v209 offset:128
    v_mfma_f32_16x16x32_bf16 v[240:243], v[104:107], v[28:31], v[240:243]
    ds_read_b64_tr_b16 v[150:151], v209 offset:2688
    ds_read_b64_tr_b16 v[152:153], v209 offset:5120
    ds_read_b64_tr_b16 v[154:155], v209 offset:7680
    v_mfma_f32_16x16x32_bf16 v[244:247], v[108:111], v[28:31], v[244:247]
    s_waitcnt lgkmcnt(3)
    ds_read_b64_tr_b16 v[156:157], v209 offset:5152
    ds_read_b64_tr_b16 v[158:159], v209 offset:7712
    ds_read_b64_tr_b16 v[160:161], v209 offset:5184
    v_mfma_f32_16x16x32_bf16 v[228:231], v[112:115], v[32:35], v[228:231]
    ds_read_b64_tr_b16 v[162:163], v209 offset:7744
    ds_read_b64_tr_b16 v[164:165], v209 offset:5216
    ds_read_b64_tr_b16 v[166:167], v209 offset:7776
    v_mfma_f32_16x16x32_bf16 v[232:235], v[116:119], v[32:35], v[232:235]
    ds_read_b64_tr_b16 v[168:169], v209 offset:5248
    ds_read_b64_tr_b16 v[170:171], v209 offset:7808
    ds_read_b64_tr_b16 v[174:175], v211 offset:0
    v_mfma_f32_16x16x32_bf16 v[236:239], v[120:123], v[32:35], v[236:239]
    s_waitcnt lgkmcnt(3)
    ds_read_b64_tr_b16 v[178:179], v211 offset:32
    ds_read_b64_tr_b16 v[182:183], v211 offset:64
    ds_read_b64_tr_b16 v[186:187], v211 offset:96
    v_mfma_f32_16x16x32_bf16 v[240:243], v[124:127], v[32:35], v[240:243]
    ds_read_b64_tr_b16 v[190:191], v211 offset:128
    v_mfma_f32_16x16x32_bf16 v[244:247], v[128:131], v[32:35], v[244:247]
    s_andn2_b32 s23, s36, s35
    s_cbranch_scc1 L_is5
L_ip5:
    global_load_dwordx2 v[10:11], v208, s[84:85] sc1
    s_waitcnt vmcnt(0)
    v_cmp_eq_u64 vcc, s[86:87], v[10:11]
    s_sub_u32 s43, s43, 1
    s_cselect_b32 vcc_lo, -1, vcc_lo
    s_lshr_b32 s23, vcc_lo, 1
    s_and_b32 s23, s23, vcc_lo
    s_lshr_b32 s24, s23, 2
    s_and_b32 s23, s23, s24
    s_and_b32 s36, s23, 0x11111111
    s_andn2_b32 s23, s36, s35
    s_cbranch_scc0 L_ip5
L_is5:
    s_ff1_i32_b32 s12, s23
    s_bitset1_b32 s35, s12
    s_lshl_b32 s23, s12, 16
    s_add_u32 s24, s23, 131072
    s_lshl_b32 s25, s12, 14
    s_add_u32 s25, s25, 2097280
    buffer_load_dwordx2 v[86:87], v207, s[8:11], s25 offen sc1
    buffer_load_dwordx4 v[52:55], v206, s[8:11], s23 offen sc1
    buffer_load_dwordx4 v[56:59], v206, s[8:11], s24 offen sc1
    s_waitcnt vmcnt(6) lgkmcnt(0)
    s_mul_i32 s23, s7, 2560
    s_mul_i32 s24, s7, 640
    s_add_u32 s24, s24, 81920
    v_add_u32 v209, s23, v210
    v_add_u32 v211, s24, v210
    v_mfma_f32_16x16x32_bf16 v[228:231], v[172:175], v[80:83], v[228:231]
    ds_read_b64_tr_b16 v[92:93], v209 offset:0
    ds_read_b64_tr_b16 v[94:95], v209 offset:2560
    v_mfma_f32_16x16x32_bf16 v[232:235], v[176:179], v[80:83], v[232:235]
    ds_read_b64_tr_b16 v[96:97], v209 offset:32
    ds_read_b64_tr_b16 v[98:99], v209 offset:2592
    v_mfma_f32_16x16x32_bf16 v[236:239], v[180:183], v[80:83], v[236:239]
    ds_read_b64_tr_b16 v[100:101], v209 offset:64
    ds_read_b64_tr_b16 v[102:103], v209 offset:2624
    v_mfma_f32_16x16x32_bf16 v[240:243], v[184:187], v[80:83], v[240:243]
    ds_read_b64_tr_b16 v[104:105], v209 offset:96
    ds_read_b64_tr_b16 v[106:107], v209 offset:2656
    v_mfma_f32_16x16x32_bf16 v[244:247], v[188:191], v[80:83], v[244:247]
    ds_read_b64_tr_b16 v[108:109], v209 offset:128
    ds_read_b64_tr_b16 v[110:111], v209 offset:2688
    v_mfma_f32_16x16x32_bf16 v[228:231], v[132:135], v[36:39], v[228:231]
    ds_read_b64_tr_b16 v[112:113], v209 offset:5120
    ds_read_b64_tr_b16 v[114:115], v209 offset:7680
    v_mfma_f32_16x16x32_bf16 v[232:235], v[136:139], v[36:39], v[232:235]
    s_waitcnt lgkmcnt(3)
    ds_read_b64_tr_b16 v[116:117], v209 offset:5152
    ds_read_b64_tr_b16 v[118:119], v209 offset:7712
    v_mfma_f32_16x16x32_bf16 v[236:239], v[140:143], v[36:39], v[236:239]
    ds_read_b64_tr_b16 v[120:121], v209 offset:5184
    ds_read_b64_tr_b16 v[122:123], v209 offset:7744
    v_mfma_f32_16x16x32_bf16 v[240:243], v[144:147], v[36:39], v[240:243]
    ds_read_b64_tr_b16 v[124:125], v209 offset:5216
    ds_read_b64_tr_b16 v[126:127], v209 offset:7776
    v_mfma_f32_16x16x32_bf16 v[244:247], v[148:151], v[36:39], v[244:247]
    ds_read_b64_tr_b16 v[128:129], v209 offset:5248
    ds_read_b64_tr_b16 v[130:131], v209 offset:7808
    v_mfma_f32_16x16x32_bf16 v[228:231], v[152:155], v[40:43], v[228:231]
    s_waitcnt lgkmcnt(3)
    ds_read_b64_tr_b16 v[172:173], v211 offset:0
    ds_read_b64_tr_b16 v[176:177], v211 offset:32
    v_mfma_f32_16x16x32_bf16 v[232:235], v[156:159], v[40:43], v[232:235]
    ds_read_b64_tr_b16 v[180:181], v211 offset:64
    ds_read_b64_tr_b16 v[184:185], v211 offset:96
    v_mfma_f32_16x16x32_bf16 v[236:239], v[160:163], v[40:43], v[236:239]
    ds_read_b64_tr_b16 v[188:189], v211 offset:128
    v_mfma_f32_16x16x32_bf16 v[240:243], v[164:167], v[40:43], v[240:243]
    v_mfma_f32_16x16x32_bf16 v[244:247], v[168:171], v[40:43], v[244:247]
    s_andn2_b32 s23, s36, s35
    s_cbranch_scc1 L_is6
L_ip6:
    global_load_dwordx2 v[10:11], v208, s[84:85] sc1
    s_waitcnt vmcnt(0)
    v_cmp_eq_u64 vcc, s[86:87], v[10:11]
    s_sub_u32 s43, s43, 1
    s_cselect_b32 vcc_lo, -1, vcc_lo
    s_lshr_b32 s23, vcc_lo, 1
    s_and_b32 s23, s23, vcc_lo
    s_lshr_b32 s24, s23, 2
    s_and_b32 s23, s23, s24
    s_and_b32 s36, s23, 0x11111111
    s_andn2_b32 s23, s36, s35
    s_cbranch_scc0 L_ip6
L_is6:
    s_ff1_i32_b32 s13, s23
    s_bitset1_b32 s35, s13
    s_lshl_b32 s23, s13, 16
    s_add_u32 s24, s23, 131072
    s_lshl_b32 s25, s13, 14
    s_add_u32 s25, s25, 2097280
    buffer_load_dwordx2 v[88:89], v207, s[8:11], s25 offen sc1
    buffer_load_dwordx4 v[60:63], v206, s[8:11], s23 offen sc1
    buffer_load_dwordx4 v[64:67], v206, s[8:11], s24 offen sc1
    s_waitcnt vmcnt(6) lgkmcnt(0)
    s_mul_i32 s23, s12, 2560
    s_mul_i32 s24, s12, 640
    s_add_u32 s24, s24, 81920
    v_add_u32 v209, s23, v210
    v_add_u32 v211, s24, v210
    v_mfma_f32_16x16x32_bf16 v[228:231], v[92:95], v[44:47], v[228:231]
    ds_read_b64_tr_b16 v[132:133], v209 offset:0
    ds_read_b64_tr_b16 v[134:135], v209 offset:2560
    ds_read_b64_tr_b16 v[136:137], v209 offset:32
    v_mfma_f32_16x16x32_bf16 v[232:235], v[96:99], v[44:47], v[232:235]
    ds_read_b64_tr_b16 v[138:139], v209 offset:2592
    ds_read_b64_tr_b16 v[140:141], v209 offset:64
    ds_read_b64_tr_b16 v[142:143], v209 offset:2624
    v_mfma_f32_16x16x32_bf16 v[236:239], v[100:103], v[44:47], v[236:239]
    ds_read_b64_tr_b16 v[144:145], v209 offset:96
    ds_read_b64_tr_b16 v[146:147], v209 offset:2656
    ds_read_b64_tr_b16 v[148:149], v209 offset:128
    v_mfma_f32_16x16x32_bf16 v[240:243], v[104:107], v[44:47], v[240:243]
    ds_read_b64_tr_b16 v[150:151], v209 offset:2688
    ds_read_b64_tr_b16 v[152:153], v209 offset:5120
    ds_read_b64_tr_b16 v[154:155], v209 offset:7680
    v_mfma_f32_16x16x32_bf16 v[244:247], v[108:111], v[44:47], v[244:247]
    s_waitcnt lgkmcnt(3)
    ds_read_b64_tr_b16 v[156:157], v209 offset:5152
    ds_read_b64_tr_b16 v[158:159], v209 offset:7712
    ds_read_b64_tr_b16 v[160:161], v209 offset:5184
    v_mfma_f32_16x16x32_bf16 v[228:231], v[112:115], v[48:51], v[228:231]
    ds_read_b64_tr_b16 v[162:163], v209 offset:7744
    ds_read_b64_tr_b16 v[164:165], v209 offset:5216
    ds_read_b64_tr_b16 v[166:167], v209 offset:7776
    v_mfma_f32_16x16x32_bf16 v[232:235], v[116:119], v[48:51], v[232:235]
    ds_read_b64_tr_b16 v[168:169], v209 offset:5248
    ds_read_b64_tr_b16 v[170:171], v209 offset:7808
    ds_read_b64_tr_b16 v[174:175], v211 offset:0
    v_mfma_f32_16x16x32_bf16 v[236:239], v[120:123], v[48:51], v[236:239]
    s_waitcnt lgkmcnt(3)
    ds_read_b64_tr_b16 v[178:179], v211 offset:32
    ds_read_b64_tr_b16 v[182:183], v211 offset:64
    ds_read_b64_tr_b16 v[186:187], v211 offset:96
    v_mfma_f32_16x16x32_bf16 v[240:243], v[124:127], v[48:51], v[240:243]
    ds_read_b64_tr_b16 v[190:191], v211 offset:128
    v_mfma_f32_16x16x32_bf16 v[244:247], v[128:131], v[48:51], v[244:247]
    s_andn2_b32 s23, s36, s35
    s_cbranch_scc1 L_is7
L_ip7:
    global_load_dwordx2 v[10:11], v208, s[84:85] sc1
    s_waitcnt vmcnt(0)
    v_cmp_eq_u64 vcc, s[86:87], v[10:11]
    s_sub_u32 s43, s43, 1
    s_cselect_b32 vcc_lo, -1, vcc_lo
    s_lshr_b32 s23, vcc_lo, 1
    s_and_b32 s23, s23, vcc_lo
    s_lshr_b32 s24, s23, 2
    s_and_b32 s23, s23, s24
    s_and_b32 s36, s23, 0x11111111
    s_andn2_b32 s23, s36, s35
    s_cbranch_scc0 L_ip7
L_is7:
    s_ff1_i32_b32 s14, s23
    s_bitset1_b32 s35, s14
    s_lshl_b32 s23, s14, 16
    s_add_u32 s24, s23, 131072
    s_lshl_b32 s25, s14, 14
    s_add_u32 s25, s25, 2097280
    buffer_load_dwordx2 v[90:91], v207, s[8:11], s25 offen sc1
    buffer_load_dwordx4 v[68:71], v206, s[8:11], s23 offen sc1
    buffer_load_dwordx4 v[72:75], v206, s[8:11], s24 offen sc1
    s_waitcnt vmcnt(6) lgkmcnt(0)
    s_mul_i32 s23, s13, 2560
    s_mul_i32 s24, s13, 640
    s_add_u32 s24, s24, 81920
    v_add_u32 v209, s23, v210
    v_add_u32 v211, s24, v210
    v_mfma_f32_16x16x32_bf16 v[228:231], v[172:175], v[84:87], v[228:231]
    ds_read_b64_tr_b16 v[92:93], v209 offset:0
    ds_read_b64_tr_b16 v[94:95], v209 offset:2560
    v_mfma_f32_16x16x32_bf16 v[232:235], v[176:179], v[84:87], v[232:235]
    ds_read_b64_tr_b16 v[96:97], v209 offset:32
    ds_read_b64_tr_b16 v[98:99], v209 offset:2592
    v_mfma_f32_16x16x32_bf16 v[236:239], v[180:183], v[84:87], v[236:239]
    ds_read_b64_tr_b16 v[100:101], v209 offset:64
    ds_read_b64_tr_b16 v[102:103], v209 offset:2624
    v_mfma_f32_16x16x32_bf16 v[240:243], v[184:187], v[84:87], v[240:243]
    ds_read_b64_tr_b16 v[104:105], v209 offset:96
    ds_read_b64_tr_b16 v[106:107], v209 offset:2656
    v_mfma_f32_16x16x32_bf16 v[244:247], v[188:191], v[84:87], v[244:247]
    ds_read_b64_tr_b16 v[108:109], v209 offset:128
    ds_read_b64_tr_b16 v[110:111], v209 offset:2688
    v_mfma_f32_16x16x32_bf16 v[228:231], v[132:135], v[52:55], v[228:231]
    ds_read_b64_tr_b16 v[112:113], v209 offset:5120
    ds_read_b64_tr_b16 v[114:115], v209 offset:7680
    v_mfma_f32_16x16x32_bf16 v[232:235], v[136:139], v[52:55], v[232:235]
    s_waitcnt lgkmcnt(3)
    ds_read_b64_tr_b16 v[116:117], v209 offset:5152
    ds_read_b64_tr_b16 v[118:119], v209 offset:7712
    v_mfma_f32_16x16x32_bf16 v[236:239], v[140:143], v[52:55], v[236:239]
    ds_read_b64_tr_b16 v[120:121], v209 offset:5184
    ds_read_b64_tr_b16 v[122:123], v209 offset:7744
    v_mfma_f32_16x16x32_bf16 v[240:243], v[144:147], v[52:55], v[240:243]
    ds_read_b64_tr_b16 v[124:125], v209 offset:5216
    ds_read_b64_tr_b16 v[126:127], v209 offset:7776
    v_mfma_f32_16x16x32_bf16 v[244:247], v[148:151], v[52:55], v[244:247]
    ds_read_b64_tr_b16 v[128:129], v209 offset:5248
    ds_read_b64_tr_b16 v[130:131], v209 offset:7808
    v_mfma_f32_16x16x32_bf16 v[228:231], v[152:155], v[56:59], v[228:231]
    s_waitcnt lgkmcnt(3)
    ds_read_b64_tr_b16 v[172:173], v211 offset:0
    ds_read_b64_tr_b16 v[176:177], v211 offset:32
    v_mfma_f32_16x16x32_bf16 v[232:235], v[156:159], v[56:59], v[232:235]
    ds_read_b64_tr_b16 v[180:181], v211 offset:64
    ds_read_b64_tr_b16 v[184:185], v211 offset:96
    v_mfma_f32_16x16x32_bf16 v[236:239], v[160:163], v[56:59], v[236:239]
    ds_read_b64_tr_b16 v[188:189], v211 offset:128
    v_mfma_f32_16x16x32_bf16 v[240:243], v[164:167], v[56:59], v[240:243]
    v_mfma_f32_16x16x32_bf16 v[244:247], v[168:171], v[56:59], v[244:247]
    s_waitcnt vmcnt(3) lgkmcnt(0)
    s_mul_i32 s23, s14, 2560
    s_mul_i32 s24, s14, 640
    s_add_u32 s24, s24, 81920
    v_add_u32 v209, s23, v210
    v_add_u32 v211, s24, v210
    v_mfma_f32_16x16x32_bf16 v[228:231], v[92:95], v[60:63], v[228:231]
    ds_read_b64_tr_b16 v[132:133], v209 offset:0
    ds_read_b64_tr_b16 v[134:135], v209 offset:2560
    ds_read_b64_tr_b16 v[136:137], v209 offset:32
    v_mfma_f32_16x16x32_bf16 v[232:235], v[96:99], v[60:63], v[232:235]
    ds_read_b64_tr_b16 v[138:139], v209 offset:2592
    ds_read_b64_tr_b16 v[140:141], v209 offset:64
    ds_read_b64_tr_b16 v[142:143], v209 offset:2624
    v_mfma_f32_16x16x32_bf16 v[236:239], v[100:103], v[60:63], v[236:239]
    ds_read_b64_tr_b16 v[144:145], v209 offset:96
    ds_read_b64_tr_b16 v[146:147], v209 offset:2656
    ds_read_b64_tr_b16 v[148:149], v209 offset:128
    v_mfma_f32_16x16x32_bf16 v[240:243], v[104:107], v[60:63], v[240:243]
    ds_read_b64_tr_b16 v[150:151], v209 offset:2688
    ds_read_b64_tr_b16 v[152:153], v209 offset:5120
    ds_read_b64_tr_b16 v[154:155], v209 offset:7680
    v_mfma_f32_16x16x32_bf16 v[244:247], v[108:111], v[60:63], v[244:247]
    s_waitcnt lgkmcnt(3)
    ds_read_b64_tr_b16 v[156:157], v209 offset:5152
    ds_read_b64_tr_b16 v[158:159], v209 offset:7712
    ds_read_b64_tr_b16 v[160:161], v209 offset:5184
    v_mfma_f32_16x16x32_bf16 v[228:231], v[112:115], v[64:67], v[228:231]
    ds_read_b64_tr_b16 v[162:163], v209 offset:7744
    ds_read_b64_tr_b16 v[164:165], v209 offset:5216
    ds_read_b64_tr_b16 v[166:167], v209 offset:7776
    v_mfma_f32_16x16x32_bf16 v[232:235], v[116:119], v[64:67], v[232:235]
    ds_read_b64_tr_b16 v[168:169], v209 offset:5248
    ds_read_b64_tr_b16 v[170:171], v209 offset:7808
    ds_read_b64_tr_b16 v[174:175], v211 offset:0
    v_mfma_f32_16x16x32_bf16 v[236:239], v[120:123], v[64:67], v[236:239]
    s_waitcnt lgkmcnt(3)
    ds_read_b64_tr_b16 v[178:179], v211 offset:32
    ds_read_b64_tr_b16 v[182:183], v211 offset:64
    ds_read_b64_tr_b16 v[186:187], v211 offset:96
    v_mfma_f32_16x16x32_bf16 v[240:243], v[124:127], v[64:67], v[240:243]
    ds_read_b64_tr_b16 v[190:191], v211 offset:128
    v_mfma_f32_16x16x32_bf16 v[244:247], v[128:131], v[64:67], v[244:247]
    s_waitcnt vmcnt(0) lgkmcnt(0)
    v_mfma_f32_16x16x32_bf16 v[228:231], v[172:175], v[88:91], v[228:231]
    v_mfma_f32_16x16x32_bf16 v[232:235], v[176:179], v[88:91], v[232:235]
    v_mfma_f32_16x16x32_bf16 v[236:239], v[180:183], v[88:91], v[236:239]
    v_mfma_f32_16x16x32_bf16 v[240:243], v[184:187], v[88:91], v[240:243]
    v_mfma_f32_16x16x32_bf16 v[244:247], v[188:191], v[88:91], v[244:247]
    v_mfma_f32_16x16x32_bf16 v[228:231], v[132:135], v[68:71], v[228:231]
    v_mfma_f32_16x16x32_bf16 v[232:235], v[136:139], v[68:71], v[232:235]
    v_mfma_f32_16x16x32_bf16 v[236:239], v[140:143], v[68:71], v[236:239]
    v_mfma_f32_16x16x32_bf16 v[240:243], v[144:147], v[68:71], v[240:243]
    v_mfma_f32_16x16x32_bf16 v[244:247], v[148:151], v[68:71], v[244:247]
    v_mfma_f32_16x16x32_bf16 v[228:231], v[152:155], v[72:75], v[228:231]
    v_mfma_f32_16x16x32_bf16 v[232:235], v[156:159], v[72:75], v[232:235]
    v_mfma_f32_16x16x32_bf16 v[236:239], v[160:163], v[72:75], v[236:239]
    v_mfma_f32_16x16x32_bf16 v[240:243], v[164:167], v[72:75], v[240:243]
    v_mfma_f32_16x16x32_bf16 v[244:247], v[168:171], v[72:75], v[244:247]
    s_nop 3
    v_cvt_pk_bf16_f32 v12, v228, v229
    v_cvt_pk_bf16_f32 v13, v230, v231
    v_cvt_pk_bf16_f32 v14, v232, v233
    v_cvt_pk_bf16_f32 v15, v234, v235
    s_nop 1
    v_permlane16_swap_b32 v12, v14
    v_permlane16_swap_b32 v13, v15
    buffer_store_dwordx4 v[12:15], v212, s[16:19], 0 offen offset:0
    v_cvt_pk_bf16_f32 v16, v236, v237
    v_cvt_pk_bf16_f32 v17, v238, v239
    v_cvt_pk_bf16_f32 v18, v240, v241
    v_cvt_pk_bf16_f32 v19, v242, v243
    s_nop 1
    v_permlane16_swap_b32 v16, v18
    v_permlane16_swap_b32 v17, v19
    buffer_store_dwordx4 v[16:19], v212, s[16:19], 0 offen offset:64
    v_cvt_pk_bf16_f32 v20, v244, v245
    v_cvt_pk_bf16_f32 v21, v246, v247
    buffer_store_dwordx2 v[20:21], v213, s[16:19], 0 offen offset:128
L_end:
    s_endpgm
L_wpf:
    s_mov_b32 s25, s20
L_wpl:
    s_mul_i32 s23, s25, 5120
    s_mul_i32 s24, s25, 51200
    s_add_u32 m0, s23, 10496
    s_nop 0
    buffer_load_dwordx4 v196, s[92:95], s24 offen lds
    s_add_u32 m0, s23, 11520
    s_nop 0
    buffer_load_dwordx4 v197, s[92:95], s24 offen lds
    s_add_u32 m0, s23, 12544
    s_nop 0
    buffer_load_dwordx4 v198, s[92:95], s24 offen lds
    s_add_u32 m0, s23, 13568
    s_nop 0
    buffer_load_dwordx4 v199, s[92:95], s24 offen lds
    s_add_u32 m0, s23, 14592
    s_nop 0
    buffer_load_dwordx4 v200, s[92:95], s24 offen lds
    s_add_u32 s25, s25, 4
    s_cmp_lt_u32 s25, 14
    s_cbranch_scc1 L_wpl
    s_mov_b32 s23, 163840
    s_mul_i32 s24, s20, 204800
    s_add_u32 m0, s23, 10496
    s_nop 0
    buffer_load_dwordx4 v201, s[92:95], s24 offen lds
    s_add_u32 m0, s23, 11520
    s_nop 0
    buffer_load_dwordx4 v202, s[92:95], s24 offen lds
    s_add_u32 m0, s23, 12544
    s_nop 0
    buffer_load_dwordx4 v203, s[92:95], s24 offen lds
    s_add_u32 m0, s23, 13568
    s_nop 0
    buffer_load_dwordx4 v204, s[92:95], s24 offen lds
    s_add_u32 m0, s23, 14592
    s_nop 0
    buffer_load_dwordx4 v205, s[92:95], s24 offen lds
    s_cmp_ge_u32 s25, 16
    s_cbranch_scc1 L_loop
    s_mul_i32 s24, s25, 51200
    s_add_u32 m0, s23, 10496
    s_nop 0
    buffer_load_dwordx4 v196, s[92:95], s24 offen lds
    s_add_u32 m0, s23, 11520
    s_nop 0
    buffer_load_dwordx4 v197, s[92:95], s24 offen lds
    s_add_u32 m0, s23, 12544
    s_nop 0
    buffer_load_dwordx4 v198, s[92:95], s24 offen lds
    s_add_u32 m0, s23, 13568
    s_nop 0
    buffer_load_dwordx4 v199, s[92:95], s24 offen lds
    s_add_u32 m0, s23, 14592
    s_nop 0
    buffer_load_dwordx4 v200, s[92:95], s24 offen lds
    s_branch L_loop
L_bal1:
    s_setprio 0
    s_branch L_bal1r
L_bal:
    s_setprio 0
    s_branch L_balr
L_fallback:
    v_subrev_u32 v12, 125952, v12
    v_subrev_u32 v14, 125952, v14
    v_subrev_u32 v16, 125952, v16
    v_mov_b32 v69, 0
    v_mov_b32 v71, 0
    v_mov_b32 v20, 0xff800000
    v_mov_b32 v21, 0xff800000
    s_mov_b32 s33, 0
L_fb1:
    buffer_load_dwordx4 v[72:75], v12, s[8:11], s33 offen sc1
    buffer_load_dword v80, v14, s[8:11], s33 offen offset:1024 sc1
    s_waitcnt vmcnt(0)
    v_mfma_f32_32x32x16_bf16 v[100:115], v[72:75], v[60:63], 0
    v_mfma_f32_32x32x8_bf16 v[100:115], v[80:81], v[68:69], v[100:115]
    v_mfma_f32_32x32x16_bf16 v[132:147], v[72:75], v[64:67], 0
    v_mfma_f32_32x32x8_bf16 v[132:147], v[80:81], v[70:71], v[132:147]
    s_add_u32 s33, s33, 2624
    s_nop 8
    v_max3_f32 v20, v100, v101, v20
    v_max3_f32 v20, v102, v103, v20
    v_max3_f32 v20, v104, v105, v20
    v_max3_f32 v20, v106, v107, v20
    v_max3_f32 v20, v108, v109, v20
    v_max3_f32 v20, v110, v111, v20
    v_max3_f32 v20, v112, v113, v20
    v_max3_f32 v20, v114, v115, v20
    v_max3_f32 v21, v132, v133, v21
    v_max3_f32 v21, v134, v135, v21
    v_max3_f32 v21, v136, v137, v21
    v_max3_f32 v21, v138, v139, v21
    v_max3_f32 v21, v140, v141, v21
    v_max3_f32 v21, v142, v143, v21
    v_max3_f32 v21, v144, v145, v21
    v_max3_f32 v21, v146, v147, v21
    s_cmp_lt_u32 s33, 167936
    s_cbranch_scc1 L_fb1
    v_mov_b32 v2, v20
    v_mov_b32 v3, v21
    s_nop 1
    v_permlane32_swap_b32 v2, v20
    v_permlane32_swap_b32 v3, v21
    s_nop 1
    v_max_f32 v20, v20, v2
    v_max_f32 v21, v21, v3
    v_mov_b32 v164, 0
    v_mov_b32 v165, 0
    v_mov_b32 v166, 0
    v_mov_b32 v167, 0
    v_mov_b32 v168, 0
    v_mov_b32 v169, 0
    v_mov_b32 v170, 0
    v_mov_b32 v171, 0
    v_mov_b32 v172, 0
    v_mov_b32 v173, 0
    v_mov_b32 v174, 0
    v_mov_b32 v175, 0
    v_mov_b32 v176, 0
    v_mov_b32 v177, 0
    v_mov_b32 v178, 0
    v_mov_b32 v179, 0
    v_mov_b32 v180, 0
    v_mov_b32 v181, 0
    v_mov_b32 v182, 0
    v_mov_b32 v183, 0
    v_mov_b32 v184, 0
    v_mov_b32 v185, 0
    v_mov_b32 v186, 0
    v_mov_b32 v187, 0
    v_mov_b32 v188, 0
    v_mov_b32 v189, 0
    v_mov_b32 v190, 0
    v_mov_b32 v191, 0
    v_mov_b32 v192, 0
    v_mov_b32 v193, 0
    v_mov_b32 v194, 0
    v_mov_b32 v195, 0
    s_mov_b32 s33, 0
L_fb2:
    buffer_load_dwordx4 v[72:75], v12, s[8:11], s33 offen sc1
    buffer_load_dword v80, v14, s[8:11], s33 offen offset:1024 sc1
    buffer_load_dwordx4 v[84:87], v16, s[8:11], s33 offen offset:1280 sc1
    buffer_load_dwordx4 v[88:91], v16, s[8:11], s33 offen offset:1952 sc1
    s_waitcnt vmcnt(0)
    v_mfma_f32_32x32x16_bf16 v[100:115], v[72:75], v[60:63], 0
    v_mfma_f32_32x32x8_bf16 v[100:115], v[80:81], v[68:69], v[100:115]
    v_mfma_f32_32x32x16_bf16 v[132:147], v[72:75], v[64:67], 0
    v_mfma_f32_32x32x8_bf16 v[132:147], v[80:81], v[70:71], v[132:147]
    s_add_u32 s33, s33, 2624
    s_nop 8
    v_sub_f32 v100, v100, v20
    v_sub_f32 v101, v101, v20
    v_sub_f32 v102, v102, v20
    v_sub_f32 v103, v103, v20
    v_sub_f32 v104, v104, v20
    v_sub_f32 v105, v105, v20
    v_sub_f32 v106, v106, v20
    v_sub_f32 v107, v107, v20
    v_sub_f32 v108, v108, v20
    v_sub_f32 v109, v109, v20
    v_sub_f32 v110, v110, v20
    v_sub_f32 v111, v111, v20
    v_sub_f32 v112, v112, v20
    v_sub_f32 v113, v113, v20
    v_sub_f32 v114, v114, v20
    v_sub_f32 v115, v115, v20
    v_exp_f32 v100, v100
    v_exp_f32 v101, v101
    v_exp_f32 v102, v102
    v_exp_f32 v103, v103
    v_exp_f32 v104, v104
    v_exp_f32 v105, v105
    v_exp_f32 v106, v106
    v_exp_f32 v107, v107
    v_exp_f32 v108, v108
    v_exp_f32 v109, v109
    v_exp_f32 v110, v110
    v_exp_f32 v111, v111
    v_exp_f32 v112, v112
    v_exp_f32 v113, v113
    v_exp_f32 v114, v114
    v_exp_f32 v115, v115
    v_sub_f32 v132, v132, v21
    v_sub_f32 v133, v133, v21
    v_sub_f32 v134, v134, v21
    v_sub_f32 v135, v135, v21
    v_sub_f32 v136, v136, v21
    v_sub_f32 v137, v137, v21
    v_sub_f32 v138, v138, v21
    v_sub_f32 v139, v139, v21
    v_sub_f32 v140, v140, v21
    v_sub_f32 v141, v141, v21
    v_sub_f32 v142, v142, v21
    v_sub_f32 v143, v143, v21
    v_sub_f32 v144, v144, v21
    v_sub_f32 v145, v145, v21
    v_sub_f32 v146, v146, v21
    v_sub_f32 v147, v147, v21
    v_exp_f32 v132, v132
    v_exp_f32 v133, v133
    v_exp_f32 v134, v134
    v_exp_f32 v135, v135
    v_exp_f32 v136, v136
    v_exp_f32 v137, v137
    v_exp_f32 v138, v138
    v_exp_f32 v139, v139
    v_exp_f32 v140, v140
    v_exp_f32 v141, v141
    v_exp_f32 v142, v142
    v_exp_f32 v143, v143
    v_exp_f32 v144, v144
    v_exp_f32 v145, v145
    v_exp_f32 v146, v146
    v_exp_f32 v147, v147
    s_nop 1
    v_smfmac_f32_32x32x32_bf16 v[164:179], v[84:87], v[100:107], v18
    v_smfmac_f32_32x32x32_bf16 v[164:179], v[88:91], v[108:115], v18
    v_smfmac_f32_32x32x32_bf16 v[180:195], v[84:87], v[132:139], v18
    v_smfmac_f32_32x32x32_bf16 v[180:195], v[88:91], v[140:147], v18
    s_cmp_lt_u32 s33, 167936
    s_cbranch_scc1 L_fb2
    s_nop 15
    v_mov_b32 v177, v176
    s_nop 1
    v_permlane32_swap_b32 v176, v177
    s_nop 1
    v_mov_b32 v193, v192
    s_nop 1
    v_permlane32_swap_b32 v192, v193
    s_nop 1
    s_branch L_store
L_codeend:
.section .rodata,"a"
.p2align 6
.amdhsa_kernel concat_heads__mha_block__grouped_kv_mqa__prompt_kernel
  .amdhsa_next_free_vgpr 256
  .amdhsa_next_free_sgpr 102
  .amdhsa_accum_offset 256
  .amdhsa_group_segment_fixed_size 0
  .amdhsa_kernarg_size 88
  .amdhsa_user_sgpr_count 2
  .amdhsa_user_sgpr_kernarg_segment_ptr 1
  .amdhsa_system_sgpr_workgroup_id_x 1
.end_amdhsa_kernel
```
